```python
import torch

def _softmax(x, axis=-1):
    return torch.softmax(x, dim=axis)
def _gelu(x):
    return torch.nn.functional.gelu(x, approximate="tanh")
def _silu(x):
    return torch.nn.functional.silu(x)
def _sigmoid(x):
    return torch.sigmoid(x)
def _layernorm(x, axis=-1, eps=1e-5):
    m = x.mean(dim=axis, keepdim=True)
    v = x.var(dim=axis, keepdim=True, unbiased=False)
    return (x - m) / torch.sqrt(v + eps)
def _scatter_add(tgt, idx, src, axis=0):
    return tgt.clone().index_add_(axis, idx, src)
def _segment_sum(src, seg, n):
    out = torch.zeros((n,) + src.shape[1:], dtype=src.dtype)
    return out.index_add_(0, seg, src)
def _pad(x, pw):
    flat = tuple(v for pair in reversed(pw) for v in pair)
    return torch.nn.functional.pad(x, flat)

kernel_name = 'concat_heads__mha_block_cached__gqa_block_cached__near_ridge'

def setup_inputs():

    _w = (lambda a: (lambda t: t.to(torch.bfloat16) if t.is_floating_point() else t)(torch.as_tensor(a)))
    def _A_setup():
        B, Sq, D = 8, 96, 512
        H, Sk, Dh = 32, 512, 128
        return {
            "x": _w((lambda *s: torch.randn(*s, dtype=torch.bfloat16) * 0.8)(B, Sq, D)),
            "k_cache": _w((lambda *s: torch.randn(*s, dtype=torch.bfloat16) * 0.8)(B, H, Sk, Dh)),
            "v_cache": _w((lambda *s: torch.randn(*s, dtype=torch.bfloat16) * 0.05)(B, H, Sk, Dh)),
            "wq": _w((lambda *s: torch.randn(*s, dtype=torch.bfloat16) * 0.8)(D, H * Dh) * (D ** -0.5)),
            "wo": _w((lambda *s: torch.randn(*s, dtype=torch.bfloat16) * 0.05)(H * Dh, D) * ((H * Dh) ** -0.5)),
        }
    _A_in = _A_setup()

    def _B_setup():
        B, Sq, D = 8, 96, 512
        Hq, Hkv, Sk, Dh = 32, 32, 512, 128
        assert Hq % Hkv == 0, (Hq, Hkv)
        return {
            "x": _w((lambda *s: torch.randn(*s, dtype=torch.bfloat16) * 0.8)(B, Sq, D)),
            "k_cache": _w((lambda *s: torch.randn(*s, dtype=torch.bfloat16) * 0.8)(B, Hkv, Sk, Dh)),
            "v_cache": _w((lambda *s: torch.randn(*s, dtype=torch.bfloat16) * 0.05)(B, Hkv, Sk, Dh)),
            "wq": _w((lambda *s: torch.randn(*s, dtype=torch.bfloat16) * 0.8)(D, Hq * Dh) * (D ** -0.5)),
            "wo": _w((lambda *s: torch.randn(*s, dtype=torch.bfloat16) * 0.05)(Hq * Dh, D) * ((Hq * Dh) ** -0.5)),
        }
    _B_in = _B_setup()

    return {
        "A_x": _A_in["x"],
        "A_k_cache": _A_in["k_cache"],
        "A_v_cache": _A_in["v_cache"],
        "A_wq": _A_in["wq"],
        "A_wo": _A_in["wo"],
        "B_x": _B_in["x"],
        "B_k_cache": _B_in["k_cache"],
        "B_v_cache": _B_in["v_cache"],
        "B_wq": _B_in["wq"],
        "B_wo": _B_in["wo"],
    }

def reference(A_x, A_k_cache, A_v_cache, A_wq, A_wo, B_x, B_k_cache, B_v_cache, B_wq, B_wo):
    def _A_ref(x, k_cache, v_cache, wq, wo):
        B, Sq, D = x.shape
        H, Dh = 32, 128
        q = (lambda x, *d: x.permute(*d))((x @ wq).reshape(B, Sq, H, Dh), 0, 2, 1, 3)
        scores = torch.einsum("bhqd,bhkd->bhqk", q, k_cache) * (Dh ** -0.5)
        p = _softmax(scores, axis=-1)
        o = torch.einsum("bhqk,bhkd->bhqd", p, v_cache)
        return (lambda x, *d: x.permute(*d))(o, 0, 2, 1, 3).reshape(B, Sq, H * Dh) @ wo

    def _B_ref(x, k_cache, v_cache, wq, wo):
        B, Sq, D = x.shape
        Hq, Dh = 32, 128
        Hkv = k_cache.shape[1]
        rep = Hq // Hkv
        q = (lambda x, *d: x.permute(*d))((x @ wq).reshape(B, Sq, Hq, Dh), 0, 2, 1, 3)
        k = (lambda x, n, axis: torch.repeat_interleave(x, n, dim=axis))(k_cache, rep, axis=1)
        v = (lambda x, n, axis: torch.repeat_interleave(x, n, dim=axis))(v_cache, rep, axis=1)
        scores = torch.einsum("bhqd,bhkd->bhqk", q, k) * (Dh ** -0.5)
        p = _softmax(scores, axis=-1)
        o = torch.einsum("bhqk,bhkd->bhqd", p, v)
        return (lambda x, *d: x.permute(*d))(o, 0, 2, 1, 3).reshape(B, Sq, Hq * Dh) @ wo

    a = _A_ref(A_x, A_k_cache, A_v_cache, A_wq, A_wo)
    b = _B_ref(B_x, B_k_cache, B_v_cache, B_wq, B_wo)
    return torch.concatenate([a, b], axis=-1)
```

```asm
; @launch kernel=concat_heads__mha_block_cached__gqa_block_cached__near_ridge_kernel grid=(256,1,1) block=(512,1,1) lds=163840
; @launch kernel=red_kernel grid=(32,16,1) block=(192,1,1) lds=0
.amdgcn_target "amdgcn-amd-amdhsa--gfx950"
.text
.globl concat_heads__mha_block_cached__gqa_block_cached__near_ridge_kernel
.p2align 8
.type concat_heads__mha_block_cached__gqa_block_cached__near_ridge_kernel,@function
concat_heads__mha_block_cached__gqa_block_cached__near_ridge_kernel:
    s_cmp_ge_u32 s2, 256
    s_cbranch_scc1 L_END
    s_load_dwordx8 s[8:15], s[0:1], 0
    s_load_dwordx8 s[20:27], s[0:1], 40
    s_load_dwordx2 s[16:17], s[0:1], 32
    s_load_dwordx2 s[28:29], s[0:1], 72
    s_load_dwordx2 s[30:31], s[0:1], 96
    s_and_b32 s7, s2, 7
    s_lshr_b32 s18, s2, 3
    s_lshr_b32 s19, s18, 3
    s_lshl_b32 s7, s7, 2
    s_add_u32 s7, s7, s19
    s_lshr_b32 s4, s7, 4
    s_and_b32 s5, s7, 15
    s_and_b32 s6, s18, 7
    v_lshrrev_b32 v1, 6, v0
    v_and_b32 v0, 63, v0
    v_readfirstlane_b32 s3, v1
    s_and_b32 s7, s5, 3
    s_lshl_b32 s7, s7, 1
    s_lshr_b32 s18, s6, 1
    s_lshl_b32 s18, s18, 1
    s_add_u32 s7, s7, s18
    s_and_b32 s81, s7, 7
    s_and_b32 s7, s3, 3
    s_lshl_b32 s79, s7, 10
    v_lshrrev_b32 v1, 4, v0
    v_and_b32 v2, 15, v0
    s_lshl_b32 s18, s7, 2
    v_add_u32 v3, s18, v1
    v_and_b32 v4, 7, v3
    v_lshlrev_b32 v4, 1, v4
    v_lshrrev_b32 v5, 3, v3
    v_or_b32 v4, v4, v5
    v_xor_b32 v5, v2, v4
    v_lshlrev_b32 v5, 4, v5
    v_lshlrev_b32 v6, 8, v3
    v_add_u32 v10, v6, v5
    v_lshrrev_b32 v6, 3, v0
    v_lshlrev_b32 v6, 10, v6
    v_and_b32 v7, 7, v0
    v_xor_b32 v7, v7, v1
    v_lshlrev_b32 v7, 4, v7
    v_add_u32 v6, v6, v7
    s_mul_i32 s18, s7, 24576
    v_add_u32 v6, s18, v6
    s_and_b32 s18, s7, 1
    s_lshl_b32 s18, s18, 6
    v_xor_b32 v13, s18, v6
    v_xor_b32 v14, 64, v13
    s_mul_i32 s88, s7, 3072
    s_add_u32 s88, s88, 131072
    s_lshl_b32 s18, s7, 3
    v_add_u32 v6, s18, v1
    v_lshlrev_b32 v6, 13, v6
    v_add_u32 v11, v6, v5
    s_mul_i32 s19, s6, 98304
    s_lshl_b32 s18, s5, 9
    s_cmp_eq_u32 s4, 0
    s_waitcnt lgkmcnt(0)
    s_cselect_b32 s8, s8, s20
    s_cselect_b32 s9, s9, s21
    s_cselect_b32 s10, s10, s22
    s_cselect_b32 s11, s11, s23
    s_cselect_b32 s12, s12, s24
    s_cselect_b32 s13, s13, s25
    s_cselect_b32 s14, s14, s26
    s_cselect_b32 s15, s15, s27
    s_cselect_b32 s16, s16, s28
    s_cselect_b32 s17, s17, s29
    s_add_u32 s36, s8, s19
    s_addc_u32 s37, s9, 0
    s_mov_b32 s38, 98304
    s_mov_b32 s39, 0x00020000
    s_add_u32 s48, s14, s18
    s_addc_u32 s49, s15, 0
    s_sub_u32 s50, 4194304, s18
    s_mov_b32 s51, 0x00020000
    s_cmp_lt_u32 s3, 4
    s_cbranch_scc1 L_COMPUTE
    s_setprio 3
    s_add_u32 s82, s81, 0
    s_and_b32 s82, s82, 7
    s_lshl_b32 s82, s82, 7
    s_add_u32 m0, s88, 0
    s_add_u32 s76, s82, 0
    buffer_load_dwordx4 v13, s[36:39], s76 offen lds
    s_add_u32 m0, s88, 1024
    s_add_u32 s76, s82, 8192
    buffer_load_dwordx4 v14, s[36:39], s76 offen lds
    s_add_u32 m0, s88, 2048
    s_add_u32 s76, s82, 16384
    buffer_load_dwordx4 v13, s[36:39], s76 offen lds
    s_lshl_b32 s82, s81, 1
    s_add_u32 s82, s82, 0
    s_and_b32 s82, s82, 15
    s_lshl_b32 s82, s82, 18
    s_add_u32 m0, s79, 65536
    s_add_u32 s76, s82, 0
    buffer_load_dwordx4 v11, s[48:51], s76 offen lds
    s_add_u32 m0, s79, 73728
    s_add_u32 s76, s82, 256
    buffer_load_dwordx4 v11, s[48:51], s76 offen lds
    s_add_u32 m0, s79, 69632
    s_add_u32 s76, s82, 32768
    buffer_load_dwordx4 v11, s[48:51], s76 offen lds
    s_add_u32 m0, s79, 77824
    s_add_u32 s76, s82, 33024
    buffer_load_dwordx4 v11, s[48:51], s76 offen lds
    s_lshl_b32 s82, s81, 1
    s_add_u32 s82, s82, 1
    s_and_b32 s82, s82, 15
    s_lshl_b32 s82, s82, 18
    s_add_u32 m0, s79, 81920
    s_add_u32 s76, s82, 0
    buffer_load_dwordx4 v11, s[48:51], s76 offen lds
    s_add_u32 m0, s79, 90112
    s_add_u32 s76, s82, 256
    buffer_load_dwordx4 v11, s[48:51], s76 offen lds
    s_add_u32 m0, s79, 86016
    s_add_u32 s76, s82, 32768
    buffer_load_dwordx4 v11, s[48:51], s76 offen lds
    s_add_u32 m0, s79, 94208
    s_add_u32 s76, s82, 33024
    buffer_load_dwordx4 v11, s[48:51], s76 offen lds
    s_add_u32 s82, s81, 1
    s_and_b32 s82, s82, 7
    s_lshl_b32 s82, s82, 7
    s_add_u32 m0, s88, 12288
    s_add_u32 s76, s82, 0
    buffer_load_dwordx4 v13, s[36:39], s76 offen lds
    s_add_u32 m0, s88, 13312
    s_add_u32 s76, s82, 8192
    buffer_load_dwordx4 v14, s[36:39], s76 offen lds
    s_add_u32 m0, s88, 14336
    s_add_u32 s76, s82, 16384
    buffer_load_dwordx4 v13, s[36:39], s76 offen lds
    s_and_b32 s7, s3, 3
    s_lshl_b32 s7, s6, 22
    s_lshl_b32 s18, s5, 18
    s_add_u32 s7, s7, s18
    s_add_u32 s40, s10, s7
    s_addc_u32 s41, s11, 0
    s_mov_b32 s42, 262144
    s_mov_b32 s43, 0x00020000
    s_add_u32 s44, s12, s7
    s_addc_u32 s45, s13, 0
    s_mov_b32 s46, 262144
    s_mov_b32 s47, 0x00020000
    s_add_u32 s52, s16, s18
    s_addc_u32 s53, s17, 0
    s_mov_b32 s54, 262144
    s_mov_b32 s55, 0x00020000
    s_add_u32 s7, s6, 0
    s_and_b32 s84, s7, 3
    s_add_u32 s7, s6, 1
    s_and_b32 s85, s7, 3
    s_add_u32 s7, s6, 2
    s_and_b32 s86, s7, 3
    s_add_u32 s7, s6, 3
    s_and_b32 s87, s7, 3
    s_and_b32 s7, s3, 3
    v_lshrrev_b32 v6, 3, v0
    v_lshlrev_b32 v6, 10, v6
    v_and_b32 v7, 7, v0
    v_lshrrev_b32 v7, 1, v7
    v_xor_b32 v7, v7, v1
    v_lshlrev_b32 v7, 5, v7
    v_and_b32 v8, 1, v0
    v_lshlrev_b32 v8, 4, v8
    v_add_u32 v6, v6, v7
    v_add_u32 v6, v6, v8
    s_lshl_b32 s18, s7, 13
    v_add_u32 v12, s18, v6
    s_waitcnt vmcnt(7)
    s_barrier
    s_lshl_b32 s82, s81, 1
    s_add_u32 s82, s82, 2
    s_and_b32 s82, s82, 15
    s_lshl_b32 s82, s82, 18
    s_add_u32 m0, s79, 98304
    s_add_u32 s76, s82, 0
    buffer_load_dwordx4 v11, s[48:51], s76 offen lds
    s_add_u32 m0, s79, 106496
    s_add_u32 s76, s82, 256
    buffer_load_dwordx4 v11, s[48:51], s76 offen lds
    s_add_u32 m0, s79, 102400
    s_add_u32 s76, s82, 32768
    buffer_load_dwordx4 v11, s[48:51], s76 offen lds
    s_add_u32 m0, s79, 110592
    s_add_u32 s76, s82, 33024
    buffer_load_dwordx4 v11, s[48:51], s76 offen lds
    s_waitcnt vmcnt(7)
    s_barrier
    s_lshl_b32 s82, s81, 1
    s_add_u32 s82, s82, 3
    s_and_b32 s82, s82, 15
    s_lshl_b32 s82, s82, 18
    s_add_u32 m0, s79, 114688
    s_add_u32 s76, s82, 0
    buffer_load_dwordx4 v11, s[48:51], s76 offen lds
    s_add_u32 m0, s79, 122880
    s_add_u32 s76, s82, 256
    buffer_load_dwordx4 v11, s[48:51], s76 offen lds
    s_add_u32 m0, s79, 118784
    s_add_u32 s76, s82, 32768
    buffer_load_dwordx4 v11, s[48:51], s76 offen lds
    s_add_u32 m0, s79, 126976
    s_add_u32 s76, s82, 33024
    buffer_load_dwordx4 v11, s[48:51], s76 offen lds
    s_add_u32 s82, s81, 2
    s_and_b32 s82, s82, 7
    s_lshl_b32 s82, s82, 7
    s_add_u32 m0, s88, 0
    s_add_u32 s76, s82, 0
    buffer_load_dwordx4 v13, s[36:39], s76 offen lds
    s_add_u32 m0, s88, 1024
    s_add_u32 s76, s82, 8192
    buffer_load_dwordx4 v14, s[36:39], s76 offen lds
    s_add_u32 m0, s88, 2048
    s_add_u32 s76, s82, 16384
    buffer_load_dwordx4 v13, s[36:39], s76 offen lds
    s_waitcnt vmcnt(7)
    s_barrier
    s_lshl_b32 s82, s81, 1
    s_add_u32 s82, s82, 4
    s_and_b32 s82, s82, 15
    s_lshl_b32 s82, s82, 18
    s_add_u32 m0, s79, 65536
    s_add_u32 s76, s82, 0
    buffer_load_dwordx4 v11, s[48:51], s76 offen lds
    s_add_u32 m0, s79, 73728
    s_add_u32 s76, s82, 256
    buffer_load_dwordx4 v11, s[48:51], s76 offen lds
    s_add_u32 m0, s79, 69632
    s_add_u32 s76, s82, 32768
    buffer_load_dwordx4 v11, s[48:51], s76 offen lds
    s_add_u32 m0, s79, 77824
    s_add_u32 s76, s82, 33024
    buffer_load_dwordx4 v11, s[48:51], s76 offen lds
    s_waitcnt vmcnt(7)
    s_barrier
    s_lshl_b32 s82, s81, 1
    s_add_u32 s82, s82, 5
    s_and_b32 s82, s82, 15
    s_lshl_b32 s82, s82, 18
    s_add_u32 m0, s79, 81920
    s_add_u32 s76, s82, 0
    buffer_load_dwordx4 v11, s[48:51], s76 offen lds
    s_add_u32 m0, s79, 90112
    s_add_u32 s76, s82, 256
    buffer_load_dwordx4 v11, s[48:51], s76 offen lds
    s_add_u32 m0, s79, 86016
    s_add_u32 s76, s82, 32768
    buffer_load_dwordx4 v11, s[48:51], s76 offen lds
    s_add_u32 m0, s79, 94208
    s_add_u32 s76, s82, 33024
    buffer_load_dwordx4 v11, s[48:51], s76 offen lds
    s_add_u32 s82, s81, 3
    s_and_b32 s82, s82, 7
    s_lshl_b32 s82, s82, 7
    s_add_u32 m0, s88, 12288
    s_add_u32 s76, s82, 0
    buffer_load_dwordx4 v13, s[36:39], s76 offen lds
    s_add_u32 m0, s88, 13312
    s_add_u32 s76, s82, 8192
    buffer_load_dwordx4 v14, s[36:39], s76 offen lds
    s_add_u32 m0, s88, 14336
    s_add_u32 s76, s82, 16384
    buffer_load_dwordx4 v13, s[36:39], s76 offen lds
    s_waitcnt vmcnt(7)
    s_barrier
    s_lshl_b32 s82, s81, 1
    s_add_u32 s82, s82, 6
    s_and_b32 s82, s82, 15
    s_lshl_b32 s82, s82, 18
    s_add_u32 m0, s79, 98304
    s_add_u32 s76, s82, 0
    buffer_load_dwordx4 v11, s[48:51], s76 offen lds
    s_add_u32 m0, s79, 106496
    s_add_u32 s76, s82, 256
    buffer_load_dwordx4 v11, s[48:51], s76 offen lds
    s_add_u32 m0, s79, 102400
    s_add_u32 s76, s82, 32768
    buffer_load_dwordx4 v11, s[48:51], s76 offen lds
    s_add_u32 m0, s79, 110592
    s_add_u32 s76, s82, 33024
    buffer_load_dwordx4 v11, s[48:51], s76 offen lds
    s_waitcnt vmcnt(7)
    s_barrier
    s_lshl_b32 s82, s81, 1
    s_add_u32 s82, s82, 7
    s_and_b32 s82, s82, 15
    s_lshl_b32 s82, s82, 18
    s_add_u32 m0, s79, 114688
    s_add_u32 s76, s82, 0
    buffer_load_dwordx4 v11, s[48:51], s76 offen lds
    s_add_u32 m0, s79, 122880
    s_add_u32 s76, s82, 256
    buffer_load_dwordx4 v11, s[48:51], s76 offen lds
    s_add_u32 m0, s79, 118784
    s_add_u32 s76, s82, 32768
    buffer_load_dwordx4 v11, s[48:51], s76 offen lds
    s_add_u32 m0, s79, 126976
    s_add_u32 s76, s82, 33024
    buffer_load_dwordx4 v11, s[48:51], s76 offen lds
    s_add_u32 s82, s81, 4
    s_and_b32 s82, s82, 7
    s_lshl_b32 s82, s82, 7
    s_add_u32 m0, s88, 0
    s_add_u32 s76, s82, 0
    buffer_load_dwordx4 v13, s[36:39], s76 offen lds
    s_add_u32 m0, s88, 1024
    s_add_u32 s76, s82, 8192
    buffer_load_dwordx4 v14, s[36:39], s76 offen lds
    s_add_u32 m0, s88, 2048
    s_add_u32 s76, s82, 16384
    buffer_load_dwordx4 v13, s[36:39], s76 offen lds
    s_waitcnt vmcnt(7)
    s_barrier
    s_lshl_b32 s82, s81, 1
    s_add_u32 s82, s82, 8
    s_and_b32 s82, s82, 15
    s_lshl_b32 s82, s82, 18
    s_add_u32 m0, s79, 65536
    s_add_u32 s76, s82, 0
    buffer_load_dwordx4 v11, s[48:51], s76 offen lds
    s_add_u32 m0, s79, 73728
    s_add_u32 s76, s82, 256
    buffer_load_dwordx4 v11, s[48:51], s76 offen lds
    s_add_u32 m0, s79, 69632
    s_add_u32 s76, s82, 32768
    buffer_load_dwordx4 v11, s[48:51], s76 offen lds
    s_add_u32 m0, s79, 77824
    s_add_u32 s76, s82, 33024
    buffer_load_dwordx4 v11, s[48:51], s76 offen lds
    s_waitcnt vmcnt(7)
    s_barrier
    s_lshl_b32 s82, s81, 1
    s_add_u32 s82, s82, 9
    s_and_b32 s82, s82, 15
    s_lshl_b32 s82, s82, 18
    s_add_u32 m0, s79, 81920
    s_add_u32 s76, s82, 0
    buffer_load_dwordx4 v11, s[48:51], s76 offen lds
    s_add_u32 m0, s79, 90112
    s_add_u32 s76, s82, 256
    buffer_load_dwordx4 v11, s[48:51], s76 offen lds
    s_add_u32 m0, s79, 86016
    s_add_u32 s76, s82, 32768
    buffer_load_dwordx4 v11, s[48:51], s76 offen lds
    s_add_u32 m0, s79, 94208
    s_add_u32 s76, s82, 33024
    buffer_load_dwordx4 v11, s[48:51], s76 offen lds
    s_add_u32 s82, s81, 5
    s_and_b32 s82, s82, 7
    s_lshl_b32 s82, s82, 7
    s_add_u32 m0, s88, 12288
    s_add_u32 s76, s82, 0
    buffer_load_dwordx4 v13, s[36:39], s76 offen lds
    s_add_u32 m0, s88, 13312
    s_add_u32 s76, s82, 8192
    buffer_load_dwordx4 v14, s[36:39], s76 offen lds
    s_add_u32 m0, s88, 14336
    s_add_u32 s76, s82, 16384
    buffer_load_dwordx4 v13, s[36:39], s76 offen lds
    s_waitcnt vmcnt(7)
    s_barrier
    s_lshl_b32 s82, s81, 1
    s_add_u32 s82, s82, 10
    s_and_b32 s82, s82, 15
    s_lshl_b32 s82, s82, 18
    s_add_u32 m0, s79, 98304
    s_add_u32 s76, s82, 0
    buffer_load_dwordx4 v11, s[48:51], s76 offen lds
    s_add_u32 m0, s79, 106496
    s_add_u32 s76, s82, 256
    buffer_load_dwordx4 v11, s[48:51], s76 offen lds
    s_add_u32 m0, s79, 102400
    s_add_u32 s76, s82, 32768
    buffer_load_dwordx4 v11, s[48:51], s76 offen lds
    s_add_u32 m0, s79, 110592
    s_add_u32 s76, s82, 33024
    buffer_load_dwordx4 v11, s[48:51], s76 offen lds
    s_waitcnt vmcnt(7)
    s_barrier
    s_lshl_b32 s82, s81, 1
    s_add_u32 s82, s82, 11
    s_and_b32 s82, s82, 15
    s_lshl_b32 s82, s82, 18
    s_add_u32 m0, s79, 114688
    s_add_u32 s76, s82, 0
    buffer_load_dwordx4 v11, s[48:51], s76 offen lds
    s_add_u32 m0, s79, 122880
    s_add_u32 s76, s82, 256
    buffer_load_dwordx4 v11, s[48:51], s76 offen lds
    s_add_u32 m0, s79, 118784
    s_add_u32 s76, s82, 32768
    buffer_load_dwordx4 v11, s[48:51], s76 offen lds
    s_add_u32 m0, s79, 126976
    s_add_u32 s76, s82, 33024
    buffer_load_dwordx4 v11, s[48:51], s76 offen lds
    s_add_u32 s82, s81, 6
    s_and_b32 s82, s82, 7
    s_lshl_b32 s82, s82, 7
    s_add_u32 m0, s88, 0
    s_add_u32 s76, s82, 0
    buffer_load_dwordx4 v13, s[36:39], s76 offen lds
    s_add_u32 m0, s88, 1024
    s_add_u32 s76, s82, 8192
    buffer_load_dwordx4 v14, s[36:39], s76 offen lds
    s_add_u32 m0, s88, 2048
    s_add_u32 s76, s82, 16384
    buffer_load_dwordx4 v13, s[36:39], s76 offen lds
    s_waitcnt vmcnt(7)
    s_barrier
    s_lshl_b32 s82, s81, 1
    s_add_u32 s82, s82, 12
    s_and_b32 s82, s82, 15
    s_lshl_b32 s82, s82, 18
    s_add_u32 m0, s79, 65536
    s_add_u32 s76, s82, 0
    buffer_load_dwordx4 v11, s[48:51], s76 offen lds
    s_add_u32 m0, s79, 73728
    s_add_u32 s76, s82, 256
    buffer_load_dwordx4 v11, s[48:51], s76 offen lds
    s_add_u32 m0, s79, 69632
    s_add_u32 s76, s82, 32768
    buffer_load_dwordx4 v11, s[48:51], s76 offen lds
    s_add_u32 m0, s79, 77824
    s_add_u32 s76, s82, 33024
    buffer_load_dwordx4 v11, s[48:51], s76 offen lds
    s_waitcnt vmcnt(7)
    s_barrier
    s_lshl_b32 s82, s81, 1
    s_add_u32 s82, s82, 13
    s_and_b32 s82, s82, 15
    s_lshl_b32 s82, s82, 18
    s_add_u32 m0, s79, 81920
    s_add_u32 s76, s82, 0
    buffer_load_dwordx4 v11, s[48:51], s76 offen lds
    s_add_u32 m0, s79, 90112
    s_add_u32 s76, s82, 256
    buffer_load_dwordx4 v11, s[48:51], s76 offen lds
    s_add_u32 m0, s79, 86016
    s_add_u32 s76, s82, 32768
    buffer_load_dwordx4 v11, s[48:51], s76 offen lds
    s_add_u32 m0, s79, 94208
    s_add_u32 s76, s82, 33024
    buffer_load_dwordx4 v11, s[48:51], s76 offen lds
    s_add_u32 s82, s81, 7
    s_and_b32 s82, s82, 7
    s_lshl_b32 s82, s82, 7
    s_add_u32 m0, s88, 12288
    s_add_u32 s76, s82, 0
    buffer_load_dwordx4 v13, s[36:39], s76 offen lds
    s_add_u32 m0, s88, 13312
    s_add_u32 s76, s82, 8192
    buffer_load_dwordx4 v14, s[36:39], s76 offen lds
    s_add_u32 m0, s88, 14336
    s_add_u32 s76, s82, 16384
    buffer_load_dwordx4 v13, s[36:39], s76 offen lds
    s_waitcnt vmcnt(7)
    s_barrier
    s_lshl_b32 s82, s81, 1
    s_add_u32 s82, s82, 14
    s_and_b32 s82, s82, 15
    s_lshl_b32 s82, s82, 18
    s_add_u32 m0, s79, 98304
    s_add_u32 s76, s82, 0
    buffer_load_dwordx4 v11, s[48:51], s76 offen lds
    s_add_u32 m0, s79, 106496
    s_add_u32 s76, s82, 256
    buffer_load_dwordx4 v11, s[48:51], s76 offen lds
    s_add_u32 m0, s79, 102400
    s_add_u32 s76, s82, 32768
    buffer_load_dwordx4 v11, s[48:51], s76 offen lds
    s_add_u32 m0, s79, 110592
    s_add_u32 s76, s82, 33024
    buffer_load_dwordx4 v11, s[48:51], s76 offen lds
    s_waitcnt vmcnt(7)
    s_barrier
    s_lshl_b32 s82, s81, 1
    s_add_u32 s82, s82, 15
    s_and_b32 s82, s82, 15
    s_lshl_b32 s82, s82, 18
    s_add_u32 m0, s79, 114688
    s_add_u32 s76, s82, 0
    buffer_load_dwordx4 v11, s[48:51], s76 offen lds
    s_add_u32 m0, s79, 122880
    s_add_u32 s76, s82, 256
    buffer_load_dwordx4 v11, s[48:51], s76 offen lds
    s_add_u32 m0, s79, 118784
    s_add_u32 s76, s82, 32768
    buffer_load_dwordx4 v11, s[48:51], s76 offen lds
    s_add_u32 m0, s79, 126976
    s_add_u32 s76, s82, 33024
    buffer_load_dwordx4 v11, s[48:51], s76 offen lds
    s_waitcnt vmcnt(4)
    s_barrier
    s_add_u32 m0, s79, 65536
    s_mov_b32 s76, 16384
    buffer_load_dwordx4 v10, s[40:43], s76 offen nt lds
    s_add_u32 m0, s79, 69632
    s_mov_b32 s76, 20480
    buffer_load_dwordx4 v10, s[40:43], s76 offen nt lds
    s_add_u32 m0, s79, 73728
    s_mov_b32 s76, 24576
    buffer_load_dwordx4 v10, s[40:43], s76 offen nt lds
    s_add_u32 m0, s79, 77824
    s_mov_b32 s76, 28672
    buffer_load_dwordx4 v10, s[40:43], s76 offen nt lds
    s_waitcnt vmcnt(4)
    s_barrier
    s_add_u32 m0, s79, 81920
    s_mov_b32 s76, 147456
    buffer_load_dwordx4 v10, s[40:43], s76 offen nt lds
    s_add_u32 m0, s79, 86016
    s_mov_b32 s76, 151552
    buffer_load_dwordx4 v10, s[40:43], s76 offen nt lds
    s_add_u32 m0, s79, 90112
    s_mov_b32 s76, 155648
    buffer_load_dwordx4 v10, s[40:43], s76 offen nt lds
    s_add_u32 m0, s79, 94208
    s_mov_b32 s76, 159744
    buffer_load_dwordx4 v10, s[40:43], s76 offen nt lds
    s_barrier
    s_add_u32 m0, s79, 98304
    s_mov_b32 s76, 16384
    buffer_load_dwordx4 v10, s[44:47], s76 offen nt lds
    s_add_u32 m0, s79, 102400
    s_mov_b32 s76, 20480
    buffer_load_dwordx4 v10, s[44:47], s76 offen nt lds
    s_add_u32 m0, s79, 106496
    s_mov_b32 s76, 24576
    buffer_load_dwordx4 v10, s[44:47], s76 offen nt lds
    s_add_u32 m0, s79, 110592
    s_mov_b32 s76, 28672
    buffer_load_dwordx4 v10, s[44:47], s76 offen nt lds
    s_add_u32 m0, s79, 114688
    s_mov_b32 s76, 147456
    buffer_load_dwordx4 v10, s[44:47], s76 offen nt lds
    s_add_u32 m0, s79, 118784
    s_mov_b32 s76, 151552
    buffer_load_dwordx4 v10, s[44:47], s76 offen nt lds
    s_add_u32 m0, s79, 122880
    s_mov_b32 s76, 155648
    buffer_load_dwordx4 v10, s[44:47], s76 offen nt lds
    s_add_u32 m0, s79, 126976
    s_mov_b32 s76, 159744
    buffer_load_dwordx4 v10, s[44:47], s76 offen nt lds
    s_barrier
    s_add_u32 m0, s79, 0
    s_mov_b32 s76, 32768
    buffer_load_dwordx4 v10, s[40:43], s76 offen nt lds
    s_add_u32 m0, s79, 4096
    s_mov_b32 s76, 36864
    buffer_load_dwordx4 v10, s[40:43], s76 offen nt lds
    s_add_u32 m0, s79, 8192
    s_mov_b32 s76, 40960
    buffer_load_dwordx4 v10, s[40:43], s76 offen nt lds
    s_add_u32 m0, s79, 12288
    s_mov_b32 s76, 45056
    buffer_load_dwordx4 v10, s[40:43], s76 offen nt lds
    s_add_u32 m0, s79, 16384
    s_mov_b32 s76, 163840
    buffer_load_dwordx4 v10, s[40:43], s76 offen nt lds
    s_add_u32 m0, s79, 20480
    s_mov_b32 s76, 167936
    buffer_load_dwordx4 v10, s[40:43], s76 offen nt lds
    s_add_u32 m0, s79, 24576
    s_mov_b32 s76, 172032
    buffer_load_dwordx4 v10, s[40:43], s76 offen nt lds
    s_add_u32 m0, s79, 28672
    s_mov_b32 s76, 176128
    buffer_load_dwordx4 v10, s[40:43], s76 offen nt lds
    s_mov_b32 s64, 5
    s_mov_b32 s77, 32768
    s_mov_b32 s78, s79
L_LD_LOOP:
    s_waitcnt vmcnt(16)
    s_barrier
    s_add_u32 m0, s78, 32768
    s_add_u32 s76, s77, 0
    buffer_load_dwordx4 v10, s[44:47], s76 offen nt lds
    s_add_u32 m0, s78, 36864
    s_add_u32 s76, s77, 4096
    buffer_load_dwordx4 v10, s[44:47], s76 offen nt lds
    s_add_u32 m0, s78, 40960
    s_add_u32 s76, s77, 8192
    buffer_load_dwordx4 v10, s[44:47], s76 offen nt lds
    s_add_u32 m0, s78, 45056
    s_add_u32 s76, s77, 12288
    buffer_load_dwordx4 v10, s[44:47], s76 offen nt lds
    s_add_u32 m0, s78, 49152
    s_add_u32 s76, s77, 131072
    buffer_load_dwordx4 v10, s[44:47], s76 offen nt lds
    s_add_u32 m0, s78, 53248
    s_add_u32 s76, s77, 135168
    buffer_load_dwordx4 v10, s[44:47], s76 offen nt lds
    s_add_u32 m0, s78, 57344
    s_add_u32 s76, s77, 139264
    buffer_load_dwordx4 v10, s[44:47], s76 offen nt lds
    s_add_u32 m0, s78, 61440
    s_add_u32 s76, s77, 143360
    buffer_load_dwordx4 v10, s[44:47], s76 offen nt lds
    s_add_u32 s77, s77, 16384
    s_xor_b32 s78, s78, 65536
    s_waitcnt vmcnt(16)
    s_barrier
    s_add_u32 m0, s78, 0
    s_add_u32 s76, s77, 0
    buffer_load_dwordx4 v10, s[40:43], s76 offen nt lds
    s_add_u32 m0, s78, 4096
    s_add_u32 s76, s77, 4096
    buffer_load_dwordx4 v10, s[40:43], s76 offen nt lds
    s_add_u32 m0, s78, 8192
    s_add_u32 s76, s77, 8192
    buffer_load_dwordx4 v10, s[40:43], s76 offen nt lds
    s_add_u32 m0, s78, 12288
    s_add_u32 s76, s77, 12288
    buffer_load_dwordx4 v10, s[40:43], s76 offen nt lds
    s_add_u32 m0, s78, 16384
    s_add_u32 s76, s77, 131072
    buffer_load_dwordx4 v10, s[40:43], s76 offen nt lds
    s_add_u32 m0, s78, 20480
    s_add_u32 s76, s77, 135168
    buffer_load_dwordx4 v10, s[40:43], s76 offen nt lds
    s_add_u32 m0, s78, 24576
    s_add_u32 s76, s77, 139264
    buffer_load_dwordx4 v10, s[40:43], s76 offen nt lds
    s_add_u32 m0, s78, 28672
    s_add_u32 s76, s77, 143360
    buffer_load_dwordx4 v10, s[40:43], s76 offen nt lds
    s_sub_u32 s64, s64, 1
    s_cmp_lg_u32 s64, 0
    s_cbranch_scc1 L_LD_LOOP
    s_waitcnt vmcnt(16)
    s_barrier
    s_add_u32 m0, s79, 98304
    s_mov_b32 s76, 114688
    buffer_load_dwordx4 v10, s[44:47], s76 offen nt lds
    s_add_u32 m0, s79, 102400
    s_mov_b32 s76, 118784
    buffer_load_dwordx4 v10, s[44:47], s76 offen nt lds
    s_add_u32 m0, s79, 106496
    s_mov_b32 s76, 122880
    buffer_load_dwordx4 v10, s[44:47], s76 offen nt lds
    s_add_u32 m0, s79, 110592
    s_mov_b32 s76, 126976
    buffer_load_dwordx4 v10, s[44:47], s76 offen nt lds
    s_add_u32 m0, s79, 114688
    s_mov_b32 s76, 245760
    buffer_load_dwordx4 v10, s[44:47], s76 offen nt lds
    s_add_u32 m0, s79, 118784
    s_mov_b32 s76, 249856
    buffer_load_dwordx4 v10, s[44:47], s76 offen nt lds
    s_add_u32 m0, s79, 122880
    s_mov_b32 s76, 253952
    buffer_load_dwordx4 v10, s[44:47], s76 offen nt lds
    s_add_u32 m0, s79, 126976
    s_mov_b32 s76, 258048
    buffer_load_dwordx4 v10, s[44:47], s76 offen nt lds
    s_waitcnt vmcnt(16)
    s_barrier
    s_lshl_b32 s82, s84, 7
    s_add_u32 m0, s79, 131072
    s_add_u32 s76, s82, 0
    buffer_load_dwordx4 v12, s[52:55], s76 offen lds
    s_add_u32 m0, s79, 135168
    s_add_u32 s76, s82, 32768
    buffer_load_dwordx4 v12, s[52:55], s76 offen lds
    s_add_u32 m0, s79, 139264
    s_add_u32 s76, s82, 65536
    buffer_load_dwordx4 v12, s[52:55], s76 offen lds
    s_add_u32 m0, s79, 143360
    s_add_u32 s76, s82, 98304
    buffer_load_dwordx4 v12, s[52:55], s76 offen lds
    s_lshl_b32 s82, s84, 7
    s_add_u32 m0, s79, 147456
    s_add_u32 s76, s82, 131072
    buffer_load_dwordx4 v12, s[52:55], s76 offen lds
    s_add_u32 m0, s79, 151552
    s_add_u32 s76, s82, 163840
    buffer_load_dwordx4 v12, s[52:55], s76 offen lds
    s_add_u32 m0, s79, 155648
    s_add_u32 s76, s82, 196608
    buffer_load_dwordx4 v12, s[52:55], s76 offen lds
    s_add_u32 m0, s79, 159744
    s_add_u32 s76, s82, 229376
    buffer_load_dwordx4 v12, s[52:55], s76 offen lds
    s_lshl_b32 s82, s84, 7
    s_add_u32 m0, s79, 0
    s_add_u32 s76, s82, 512
    buffer_load_dwordx4 v12, s[52:55], s76 offen lds
    s_add_u32 m0, s79, 4096
    s_add_u32 s76, s82, 33280
    buffer_load_dwordx4 v12, s[52:55], s76 offen lds
    s_add_u32 m0, s79, 8192
    s_add_u32 s76, s82, 66048
    buffer_load_dwordx4 v12, s[52:55], s76 offen lds
    s_add_u32 m0, s79, 12288
    s_add_u32 s76, s82, 98816
    buffer_load_dwordx4 v12, s[52:55], s76 offen lds
    s_lshl_b32 s82, s84, 7
    s_add_u32 m0, s79, 16384
    s_add_u32 s76, s82, 131584
    buffer_load_dwordx4 v12, s[52:55], s76 offen lds
    s_add_u32 m0, s79, 20480
    s_add_u32 s76, s82, 164352
    buffer_load_dwordx4 v12, s[52:55], s76 offen lds
    s_add_u32 m0, s79, 24576
    s_add_u32 s76, s82, 197120
    buffer_load_dwordx4 v12, s[52:55], s76 offen lds
    s_add_u32 m0, s79, 28672
    s_add_u32 s76, s82, 229888
    buffer_load_dwordx4 v12, s[52:55], s76 offen lds
    s_waitcnt vmcnt(24)
    s_barrier
    s_lshl_b32 s82, s85, 7
    s_add_u32 m0, s79, 32768
    s_add_u32 s76, s82, 0
    buffer_load_dwordx4 v12, s[52:55], s76 offen lds
    s_add_u32 m0, s79, 36864
    s_add_u32 s76, s82, 32768
    buffer_load_dwordx4 v12, s[52:55], s76 offen lds
    s_add_u32 m0, s79, 40960
    s_add_u32 s76, s82, 65536
    buffer_load_dwordx4 v12, s[52:55], s76 offen lds
    s_add_u32 m0, s79, 45056
    s_add_u32 s76, s82, 98304
    buffer_load_dwordx4 v12, s[52:55], s76 offen lds
    s_waitcnt vmcnt(20)
    s_barrier
    s_barrier
    s_lshl_b32 s82, s85, 7
    s_add_u32 m0, s79, 98304
    s_add_u32 s76, s82, 131072
    buffer_load_dwordx4 v12, s[52:55], s76 offen lds
    s_add_u32 m0, s79, 102400
    s_add_u32 s76, s82, 163840
    buffer_load_dwordx4 v12, s[52:55], s76 offen lds
    s_add_u32 m0, s79, 106496
    s_add_u32 s76, s82, 196608
    buffer_load_dwordx4 v12, s[52:55], s76 offen lds
    s_add_u32 m0, s79, 110592
    s_add_u32 s76, s82, 229376
    buffer_load_dwordx4 v12, s[52:55], s76 offen lds
    s_lshl_b32 s82, s85, 7
    s_add_u32 m0, s79, 114688
    s_add_u32 s76, s82, 512
    buffer_load_dwordx4 v12, s[52:55], s76 offen lds
    s_add_u32 m0, s79, 118784
    s_add_u32 s76, s82, 33280
    buffer_load_dwordx4 v12, s[52:55], s76 offen lds
    s_add_u32 m0, s79, 122880
    s_add_u32 s76, s82, 66048
    buffer_load_dwordx4 v12, s[52:55], s76 offen lds
    s_add_u32 m0, s79, 126976
    s_add_u32 s76, s82, 98816
    buffer_load_dwordx4 v12, s[52:55], s76 offen lds
    s_waitcnt vmcnt(12)
    s_barrier
    s_lshl_b32 s82, s85, 7
    s_add_u32 m0, s79, 49152
    s_add_u32 s76, s82, 131584
    buffer_load_dwordx4 v12, s[52:55], s76 offen lds
    s_add_u32 m0, s79, 53248
    s_add_u32 s76, s82, 164352
    buffer_load_dwordx4 v12, s[52:55], s76 offen lds
    s_add_u32 m0, s79, 57344
    s_add_u32 s76, s82, 197120
    buffer_load_dwordx4 v12, s[52:55], s76 offen lds
    s_add_u32 m0, s79, 61440
    s_add_u32 s76, s82, 229888
    buffer_load_dwordx4 v12, s[52:55], s76 offen lds
    s_lshl_b32 s82, s86, 7
    s_add_u32 m0, s79, 65536
    s_add_u32 s76, s82, 0
    buffer_load_dwordx4 v12, s[52:55], s76 offen lds
    s_add_u32 m0, s79, 69632
    s_add_u32 s76, s82, 32768
    buffer_load_dwordx4 v12, s[52:55], s76 offen lds
    s_add_u32 m0, s79, 73728
    s_add_u32 s76, s82, 65536
    buffer_load_dwordx4 v12, s[52:55], s76 offen lds
    s_add_u32 m0, s79, 77824
    s_add_u32 s76, s82, 98304
    buffer_load_dwordx4 v12, s[52:55], s76 offen lds
    s_lshl_b32 s82, s86, 7
    s_add_u32 m0, s79, 81920
    s_add_u32 s76, s82, 131072
    buffer_load_dwordx4 v12, s[52:55], s76 offen lds
    s_add_u32 m0, s79, 86016
    s_add_u32 s76, s82, 163840
    buffer_load_dwordx4 v12, s[52:55], s76 offen lds
    s_add_u32 m0, s79, 90112
    s_add_u32 s76, s82, 196608
    buffer_load_dwordx4 v12, s[52:55], s76 offen lds
    s_add_u32 m0, s79, 94208
    s_add_u32 s76, s82, 229376
    buffer_load_dwordx4 v12, s[52:55], s76 offen lds
    s_waitcnt vmcnt(8)
    s_barrier
    s_lshl_b32 s82, s86, 7
    s_add_u32 m0, s79, 131072
    s_add_u32 s76, s82, 512
    buffer_load_dwordx4 v12, s[52:55], s76 offen lds
    s_add_u32 m0, s79, 135168
    s_add_u32 s76, s82, 33280
    buffer_load_dwordx4 v12, s[52:55], s76 offen lds
    s_add_u32 m0, s79, 139264
    s_add_u32 s76, s82, 66048
    buffer_load_dwordx4 v12, s[52:55], s76 offen lds
    s_add_u32 m0, s79, 143360
    s_add_u32 s76, s82, 98816
    buffer_load_dwordx4 v12, s[52:55], s76 offen lds
    s_lshl_b32 s82, s86, 7
    s_add_u32 m0, s79, 147456
    s_add_u32 s76, s82, 131584
    buffer_load_dwordx4 v12, s[52:55], s76 offen lds
    s_add_u32 m0, s79, 151552
    s_add_u32 s76, s82, 164352
    buffer_load_dwordx4 v12, s[52:55], s76 offen lds
    s_add_u32 m0, s79, 155648
    s_add_u32 s76, s82, 197120
    buffer_load_dwordx4 v12, s[52:55], s76 offen lds
    s_add_u32 m0, s79, 159744
    s_add_u32 s76, s82, 229888
    buffer_load_dwordx4 v12, s[52:55], s76 offen lds
    s_lshl_b32 s82, s87, 7
    s_add_u32 m0, s79, 0
    s_add_u32 s76, s82, 0
    buffer_load_dwordx4 v12, s[52:55], s76 offen lds
    s_add_u32 m0, s79, 4096
    s_add_u32 s76, s82, 32768
    buffer_load_dwordx4 v12, s[52:55], s76 offen lds
    s_add_u32 m0, s79, 8192
    s_add_u32 s76, s82, 65536
    buffer_load_dwordx4 v12, s[52:55], s76 offen lds
    s_add_u32 m0, s79, 12288
    s_add_u32 s76, s82, 98304
    buffer_load_dwordx4 v12, s[52:55], s76 offen lds
    s_lshl_b32 s82, s87, 7
    s_add_u32 m0, s79, 16384
    s_add_u32 s76, s82, 131072
    buffer_load_dwordx4 v12, s[52:55], s76 offen lds
    s_add_u32 m0, s79, 20480
    s_add_u32 s76, s82, 163840
    buffer_load_dwordx4 v12, s[52:55], s76 offen lds
    s_add_u32 m0, s79, 24576
    s_add_u32 s76, s82, 196608
    buffer_load_dwordx4 v12, s[52:55], s76 offen lds
    s_add_u32 m0, s79, 28672
    s_add_u32 s76, s82, 229376
    buffer_load_dwordx4 v12, s[52:55], s76 offen lds
    s_waitcnt vmcnt(8)
    s_barrier
    s_lshl_b32 s82, s87, 7
    s_add_u32 m0, s79, 32768
    s_add_u32 s76, s82, 512
    buffer_load_dwordx4 v12, s[52:55], s76 offen lds
    s_add_u32 m0, s79, 36864
    s_add_u32 s76, s82, 33280
    buffer_load_dwordx4 v12, s[52:55], s76 offen lds
    s_add_u32 m0, s79, 40960
    s_add_u32 s76, s82, 66048
    buffer_load_dwordx4 v12, s[52:55], s76 offen lds
    s_add_u32 m0, s79, 45056
    s_add_u32 s76, s82, 98816
    buffer_load_dwordx4 v12, s[52:55], s76 offen lds
    s_lshl_b32 s82, s87, 7
    s_add_u32 m0, s79, 98304
    s_add_u32 s76, s82, 131584
    buffer_load_dwordx4 v12, s[52:55], s76 offen lds
    s_add_u32 m0, s79, 102400
    s_add_u32 s76, s82, 164352
    buffer_load_dwordx4 v12, s[52:55], s76 offen lds
    s_add_u32 m0, s79, 106496
    s_add_u32 s76, s82, 197120
    buffer_load_dwordx4 v12, s[52:55], s76 offen lds
    s_add_u32 m0, s79, 110592
    s_add_u32 s76, s82, 229888
    buffer_load_dwordx4 v12, s[52:55], s76 offen lds
    s_waitcnt vmcnt(0)
    s_barrier
    s_endpgm
L_COMPUTE:
    s_lshl_b32 s7, s6, 22
    s_lshl_b32 s18, s5, 18
    s_add_u32 s7, s7, s18
    s_add_u32 s40, s10, s7
    s_addc_u32 s41, s11, 0
    s_mov_b32 s42, 262144
    s_mov_b32 s43, 0x00020000
    s_add_u32 s44, s12, s7
    s_addc_u32 s45, s13, 0
    s_mov_b32 s46, 262144
    s_mov_b32 s47, 0x00020000
    s_lshl_b32 s7, s4, 4
    s_add_u32 s7, s7, s5
    s_lshl_b32 s7, s7, 3
    s_add_u32 s7, s7, s6
    s_mul_i32 s7, s7, 98304
    s_add_u32 s56, s30, s7
    s_addc_u32 s57, s31, 0
    s_mov_b32 s58, 98304
    s_mov_b32 s59, 0x00020000
    s_add_u32 s7, s6, 0
    s_and_b32 s84, s7, 3
    s_add_u32 s7, s6, 1
    s_and_b32 s85, s7, 3
    s_add_u32 s7, s6, 2
    s_and_b32 s86, s7, 3
    s_add_u32 s7, s6, 3
    s_and_b32 s87, s7, 3
    s_and_b32 s65, s3, 1
    s_lshr_b32 s66, s3, 1
    s_mov_b32 s89, s6
    v_mov_b32 v255, v10
    v_and_b32 v1, 15, v0
    v_lshrrev_b32 v2, 4, v0
    s_mul_i32 s7, s66, 48
    v_add_u32 v3, s7, v1
    v_lshlrev_b32 v3, 7, v3
    v_lshrrev_b32 v4, 1, v1
    v_xor_b32 v4, v4, v2
    v_lshlrev_b32 v4, 4, v4
    v_add_u32 v3, v3, v4
    v_add_u32 v251, 131072, v3
    v_xor_b32 v252, 64, v251
    s_mov_b32 s62, 0x3e0293ee
    s_mov_b32 s63, 0xbe0293ee
    v_and_b32 v5, 7, v1
    v_lshlrev_b32 v5, 1, v5
    v_lshrrev_b32 v6, 3, v1
    v_or_b32 v5, v5, v6
    v_lshrrev_b32 v6, 1, v2
    v_xor_b32 v5, v5, v6
    v_lshlrev_b32 v5, 4, v5
    v_lshlrev_b32 v6, 8, v1
    v_add_u32 v5, v5, v6
    v_and_b32 v6, 1, v2
    v_lshlrev_b32 v6, 3, v6
    v_add_u32 v5, v5, v6
    s_lshl_b32 s7, s65, 14
    v_add_u32 v224, s7, v5
    v_lshrrev_b32 v7, 2, v1
    v_lshlrev_b32 v8, 2, v2
    v_add_u32 v8, v8, v7
    v_and_b32 v9, 3, v0
    v_and_b32 v5, 7, v8
    v_lshlrev_b32 v5, 1, v5
    v_lshrrev_b32 v6, 3, v8
    v_or_b32 v5, v5, v6
    v_lshrrev_b32 v6, 1, v9
    v_xor_b32 v5, v5, v6
    v_lshlrev_b32 v5, 4, v5
    v_lshlrev_b32 v6, 8, v8
    v_add_u32 v5, v5, v6
    v_and_b32 v6, 1, v9
    v_lshlrev_b32 v6, 3, v6
    v_add_u32 v5, v5, v6
    s_add_u32 s18, s7, 32768
    v_add_u32 v225, s18, v5
    s_lshl_b32 s7, s65, 13
    v_add_u32 v226, s7, v5
    v_lshrrev_b32 v5, 1, v8
    v_and_b32 v5, 3, v5
    v_lshlrev_b32 v5, 5, v5
    v_lshlrev_b32 v6, 7, v8
    v_add_u32 v5, v5, v6
    v_lshlrev_b32 v6, 3, v9
    v_add_u32 v227, v5, v6
    s_mul_i32 s84, s84, 6144
    s_mul_i32 s85, s85, 6144
    s_mul_i32 s86, s86, 6144
    s_mul_i32 s87, s87, 6144
    s_cmp_eq_u32 s65, 0
    s_cselect_b32 s68, 8, 1
    s_cselect_b32 s69, 9, 0
    s_cselect_b32 s70, 2, 3
    s_cselect_b32 s71, 6, 7
    s_cselect_b32 s72, 4, 9
    s_cselect_b32 s73, 5, 8
    s_cselect_b32 s74, 0, 6
    s_cselect_b32 s75, 1, 2
    s_lshl_b32 s68, s68, 14
    s_lshl_b32 s69, s69, 14
    s_lshl_b32 s70, s70, 14
    s_lshl_b32 s71, s71, 14
    s_lshl_b32 s72, s72, 14
    s_lshl_b32 s73, s73, 14
    s_lshl_b32 s74, s74, 14
    s_lshl_b32 s75, s75, 14
    v_add_u32 v228, 65536, v226
    v_xor_b32 v229, 32, v228
    v_xor_b32 v230, 64, v228
    v_xor_b32 v231, 96, v228
    v_xor_b32 v232, 128, v228
    v_xor_b32 v233, 160, v228
    v_xor_b32 v234, 192, v228
    v_xor_b32 v235, 224, v228
    s_barrier
    ds_read_b128 v[0:3], v251 offset:0
    ds_read_b128 v[4:7], v251 offset:2048
    ds_read_b128 v[8:11], v251 offset:4096
    ds_read_b128 v[12:15], v252 offset:0
    ds_read_b128 v[16:19], v252 offset:2048
    ds_read_b128 v[20:23], v252 offset:4096
    ds_read_b64_tr_b16 v[192:193], v228 offset:0
    ds_read_b64_tr_b16 v[194:195], v228 offset:4096
    ds_read_b64_tr_b16 v[196:197], v229 offset:0
    ds_read_b64_tr_b16 v[198:199], v229 offset:4096
    ds_read_b64_tr_b16 v[200:201], v230 offset:0
    ds_read_b64_tr_b16 v[202:203], v230 offset:4096
    ds_read_b64_tr_b16 v[204:205], v231 offset:0
    ds_read_b64_tr_b16 v[206:207], v231 offset:4096
    ds_read_b64_tr_b16 v[208:209], v232 offset:0
    ds_read_b64_tr_b16 v[210:211], v232 offset:4096
    ds_read_b64_tr_b16 v[212:213], v233 offset:0
    ds_read_b64_tr_b16 v[214:215], v233 offset:4096
    ds_read_b64_tr_b16 v[216:217], v234 offset:0
    ds_read_b64_tr_b16 v[218:219], v234 offset:4096
    s_waitcnt lgkmcnt(12)
    v_mfma_f32_16x16x32_bf16 v[96:99], v[192:195], v[0:3], 0
    ds_read_b64_tr_b16 v[220:221], v235 offset:0
    v_mfma_f32_16x16x32_bf16 v[104:107], v[192:195], v[4:7], 0
    ds_read_b64_tr_b16 v[222:223], v235 offset:4096
    v_mfma_f32_16x16x32_bf16 v[112:115], v[192:195], v[8:11], 0
    s_waitcnt lgkmcnt(12)
    s_barrier
    v_mfma_f32_16x16x32_bf16 v[100:103], v[196:199], v[0:3], 0
    ds_read_b64_tr_b16 v[192:193], v228 offset:16384
    v_mfma_f32_16x16x32_bf16 v[108:111], v[196:199], v[4:7], 0
    ds_read_b64_tr_b16 v[194:195], v228 offset:20480
    v_mfma_f32_16x16x32_bf16 v[116:119], v[196:199], v[8:11], 0
    s_waitcnt lgkmcnt(12)
    v_mfma_f32_16x16x32_bf16 v[120:123], v[200:203], v[0:3], 0
    ds_read_b64_tr_b16 v[196:197], v229 offset:16384
    v_mfma_f32_16x16x32_bf16 v[128:131], v[200:203], v[4:7], 0
    ds_read_b64_tr_b16 v[198:199], v229 offset:20480
    v_mfma_f32_16x16x32_bf16 v[136:139], v[200:203], v[8:11], 0
    s_waitcnt lgkmcnt(12)
    v_mfma_f32_16x16x32_bf16 v[124:127], v[204:207], v[0:3], 0
    ds_read_b64_tr_b16 v[200:201], v230 offset:16384
    v_mfma_f32_16x16x32_bf16 v[132:135], v[204:207], v[4:7], 0
    ds_read_b64_tr_b16 v[202:203], v230 offset:20480
    v_mfma_f32_16x16x32_bf16 v[140:143], v[204:207], v[8:11], 0
    s_waitcnt lgkmcnt(12)
    v_mfma_f32_16x16x32_bf16 v[144:147], v[208:211], v[0:3], 0
    ds_read_b64_tr_b16 v[204:205], v231 offset:16384
    v_mfma_f32_16x16x32_bf16 v[152:155], v[208:211], v[4:7], 0
    ds_read_b64_tr_b16 v[206:207], v231 offset:20480
    v_mfma_f32_16x16x32_bf16 v[160:163], v[208:211], v[8:11], 0
    s_waitcnt lgkmcnt(12)
    v_mfma_f32_16x16x32_bf16 v[148:151], v[212:215], v[0:3], 0
    ds_read_b64_tr_b16 v[208:209], v232 offset:16384
    v_mfma_f32_16x16x32_bf16 v[156:159], v[212:215], v[4:7], 0
    ds_read_b64_tr_b16 v[210:211], v232 offset:20480
    v_mfma_f32_16x16x32_bf16 v[164:167], v[212:215], v[8:11], 0
    s_waitcnt lgkmcnt(12)
    v_mfma_f32_16x16x32_bf16 v[168:171], v[216:219], v[0:3], 0
    ds_read_b64_tr_b16 v[212:213], v233 offset:16384
    v_mfma_f32_16x16x32_bf16 v[176:179], v[216:219], v[4:7], 0
    ds_read_b64_tr_b16 v[214:215], v233 offset:20480
    v_mfma_f32_16x16x32_bf16 v[184:187], v[216:219], v[8:11], 0
    s_waitcnt lgkmcnt(12)
    v_mfma_f32_16x16x32_bf16 v[172:175], v[220:223], v[0:3], 0
    ds_read_b64_tr_b16 v[216:217], v234 offset:16384
    v_mfma_f32_16x16x32_bf16 v[180:183], v[220:223], v[4:7], 0
    ds_read_b64_tr_b16 v[218:219], v234 offset:20480
    v_mfma_f32_16x16x32_bf16 v[188:191], v[220:223], v[8:11], 0
    s_waitcnt lgkmcnt(12)
    v_mfma_f32_16x16x32_bf16 v[96:99], v[192:195], v[12:15], v[96:99]
    ds_read_b64_tr_b16 v[220:221], v235 offset:16384
    v_mfma_f32_16x16x32_bf16 v[104:107], v[192:195], v[16:19], v[104:107]
    ds_read_b64_tr_b16 v[222:223], v235 offset:20480
    v_mfma_f32_16x16x32_bf16 v[112:115], v[192:195], v[20:23], v[112:115]
    s_waitcnt lgkmcnt(12)
    s_barrier
    v_mfma_f32_16x16x32_bf16 v[100:103], v[196:199], v[12:15], v[100:103]
    ds_read_b64_tr_b16 v[192:193], v228 offset:32768
    v_mfma_f32_16x16x32_bf16 v[108:111], v[196:199], v[16:19], v[108:111]
    ds_read_b64_tr_b16 v[194:195], v228 offset:36864
    v_mfma_f32_16x16x32_bf16 v[116:119], v[196:199], v[20:23], v[116:119]
    ds_read_b128 v[24:27], v251 offset:12288
    ds_read_b128 v[28:31], v251 offset:14336
    s_waitcnt lgkmcnt(14)
    v_mfma_f32_16x16x32_bf16 v[120:123], v[200:203], v[12:15], v[120:123]
    ds_read_b64_tr_b16 v[196:197], v229 offset:32768
    v_mfma_f32_16x16x32_bf16 v[128:131], v[200:203], v[16:19], v[128:131]
    ds_read_b64_tr_b16 v[198:199], v229 offset:36864
    v_mfma_f32_16x16x32_bf16 v[136:139], v[200:203], v[20:23], v[136:139]
    ds_read_b128 v[32:35], v251 offset:16384
    ds_read_b128 v[36:39], v252 offset:12288
    s_waitcnt lgkmcnt(15)
    v_mfma_f32_16x16x32_bf16 v[124:127], v[204:207], v[12:15], v[124:127]
    ds_read_b64_tr_b16 v[200:201], v230 offset:32768
    v_mfma_f32_16x16x32_bf16 v[132:135], v[204:207], v[16:19], v[132:135]
    ds_read_b64_tr_b16 v[202:203], v230 offset:36864
    v_mfma_f32_16x16x32_bf16 v[140:143], v[204:207], v[20:23], v[140:143]
    ds_read_b128 v[40:43], v252 offset:14336
    ds_read_b128 v[44:47], v252 offset:16384
    s_waitcnt lgkmcnt(15)
    v_mfma_f32_16x16x32_bf16 v[144:147], v[208:211], v[12:15], v[144:147]
    ds_read_b64_tr_b16 v[204:205], v231 offset:32768
    v_mfma_f32_16x16x32_bf16 v[152:155], v[208:211], v[16:19], v[152:155]
    ds_read_b64_tr_b16 v[206:207], v231 offset:36864
    v_mfma_f32_16x16x32_bf16 v[160:163], v[208:211], v[20:23], v[160:163]
    v_mfma_f32_16x16x32_bf16 v[148:151], v[212:215], v[12:15], v[148:151]
    ds_read_b64_tr_b16 v[208:209], v232 offset:32768
    v_mfma_f32_16x16x32_bf16 v[156:159], v[212:215], v[16:19], v[156:159]
    ds_read_b64_tr_b16 v[210:211], v232 offset:36864
    v_mfma_f32_16x16x32_bf16 v[164:167], v[212:215], v[20:23], v[164:167]
    s_waitcnt lgkmcnt(15)
    v_mfma_f32_16x16x32_bf16 v[168:171], v[216:219], v[12:15], v[168:171]
    ds_read_b64_tr_b16 v[212:213], v233 offset:32768
    v_mfma_f32_16x16x32_bf16 v[176:179], v[216:219], v[16:19], v[176:179]
    ds_read_b64_tr_b16 v[214:215], v233 offset:36864
    v_mfma_f32_16x16x32_bf16 v[184:187], v[216:219], v[20:23], v[184:187]
    v_mfma_f32_16x16x32_bf16 v[172:175], v[220:223], v[12:15], v[172:175]
    ds_read_b64_tr_b16 v[216:217], v234 offset:32768
    v_mfma_f32_16x16x32_bf16 v[180:183], v[220:223], v[16:19], v[180:183]
    ds_read_b64_tr_b16 v[218:219], v234 offset:36864
    v_mfma_f32_16x16x32_bf16 v[188:191], v[220:223], v[20:23], v[188:191]
    s_waitcnt lgkmcnt(13)
    v_mfma_f32_16x16x32_bf16 v[96:99], v[192:195], v[24:27], v[96:99]
    ds_read_b64_tr_b16 v[220:221], v235 offset:32768
    v_mfma_f32_16x16x32_bf16 v[104:107], v[192:195], v[28:31], v[104:107]
    ds_read_b64_tr_b16 v[222:223], v235 offset:36864
    v_mfma_f32_16x16x32_bf16 v[112:115], v[192:195], v[32:35], v[112:115]
    s_waitcnt lgkmcnt(10)
    s_barrier
    v_mfma_f32_16x16x32_bf16 v[100:103], v[196:199], v[24:27], v[100:103]
    ds_read_b64_tr_b16 v[192:193], v228 offset:49152
    v_mfma_f32_16x16x32_bf16 v[108:111], v[196:199], v[28:31], v[108:111]
    ds_read_b64_tr_b16 v[194:195], v228 offset:53248
    v_mfma_f32_16x16x32_bf16 v[116:119], v[196:199], v[32:35], v[116:119]
    v_mfma_f32_16x16x32_bf16 v[120:123], v[200:203], v[24:27], v[120:123]
    ds_read_b64_tr_b16 v[196:197], v229 offset:49152
    v_mfma_f32_16x16x32_bf16 v[128:131], v[200:203], v[28:31], v[128:131]
    ds_read_b64_tr_b16 v[198:199], v229 offset:53248
    v_mfma_f32_16x16x32_bf16 v[136:139], v[200:203], v[32:35], v[136:139]
    s_waitcnt lgkmcnt(12)
    v_mfma_f32_16x16x32_bf16 v[124:127], v[204:207], v[24:27], v[124:127]
    ds_read_b64_tr_b16 v[200:201], v230 offset:49152
    v_mfma_f32_16x16x32_bf16 v[132:135], v[204:207], v[28:31], v[132:135]
    ds_read_b64_tr_b16 v[202:203], v230 offset:53248
    v_mfma_f32_16x16x32_bf16 v[140:143], v[204:207], v[32:35], v[140:143]
    s_waitcnt lgkmcnt(12)
    v_mfma_f32_16x16x32_bf16 v[144:147], v[208:211], v[24:27], v[144:147]
    ds_read_b64_tr_b16 v[204:205], v231 offset:49152
    v_mfma_f32_16x16x32_bf16 v[152:155], v[208:211], v[28:31], v[152:155]
    ds_read_b64_tr_b16 v[206:207], v231 offset:53248
    v_mfma_f32_16x16x32_bf16 v[160:163], v[208:211], v[32:35], v[160:163]
    s_waitcnt lgkmcnt(12)
    v_mfma_f32_16x16x32_bf16 v[148:151], v[212:215], v[24:27], v[148:151]
    ds_read_b64_tr_b16 v[208:209], v232 offset:49152
    v_mfma_f32_16x16x32_bf16 v[156:159], v[212:215], v[28:31], v[156:159]
    ds_read_b64_tr_b16 v[210:211], v232 offset:53248
    v_mfma_f32_16x16x32_bf16 v[164:167], v[212:215], v[32:35], v[164:167]
    s_waitcnt lgkmcnt(12)
    v_mfma_f32_16x16x32_bf16 v[168:171], v[216:219], v[24:27], v[168:171]
    ds_read_b64_tr_b16 v[212:213], v233 offset:49152
    v_mfma_f32_16x16x32_bf16 v[176:179], v[216:219], v[28:31], v[176:179]
    ds_read_b64_tr_b16 v[214:215], v233 offset:53248
    v_mfma_f32_16x16x32_bf16 v[184:187], v[216:219], v[32:35], v[184:187]
    s_waitcnt lgkmcnt(12)
    v_mfma_f32_16x16x32_bf16 v[172:175], v[220:223], v[24:27], v[172:175]
    ds_read_b64_tr_b16 v[216:217], v234 offset:49152
    v_mfma_f32_16x16x32_bf16 v[180:183], v[220:223], v[28:31], v[180:183]
    ds_read_b64_tr_b16 v[218:219], v234 offset:53248
    v_mfma_f32_16x16x32_bf16 v[188:191], v[220:223], v[32:35], v[188:191]
    s_waitcnt lgkmcnt(12)
    v_mfma_f32_16x16x32_bf16 v[96:99], v[192:195], v[36:39], v[96:99]
    ds_read_b64_tr_b16 v[220:221], v235 offset:49152
    v_mfma_f32_16x16x32_bf16 v[104:107], v[192:195], v[40:43], v[104:107]
    ds_read_b64_tr_b16 v[222:223], v235 offset:53248
    v_mfma_f32_16x16x32_bf16 v[112:115], v[192:195], v[44:47], v[112:115]
    v_mov_b32 v48, 0
    s_waitcnt lgkmcnt(12)
    s_barrier
    v_mfma_f32_16x16x32_bf16 v[100:103], v[196:199], v[36:39], v[100:103]
    ds_read_b64_tr_b16 v[192:193], v228 offset:0
    v_mfma_f32_16x16x32_bf16 v[108:111], v[196:199], v[40:43], v[108:111]
    ds_read_b64_tr_b16 v[194:195], v228 offset:4096
    v_mfma_f32_16x16x32_bf16 v[116:119], v[196:199], v[44:47], v[116:119]
    ds_read_b128 v[0:3], v251 offset:0
    ds_read_b128 v[4:7], v251 offset:2048
    v_mov_b32 v49, 0
    s_waitcnt lgkmcnt(14)
    v_mfma_f32_16x16x32_bf16 v[120:123], v[200:203], v[36:39], v[120:123]
    ds_read_b64_tr_b16 v[196:197], v229 offset:0
    v_mfma_f32_16x16x32_bf16 v[128:131], v[200:203], v[40:43], v[128:131]
    ds_read_b64_tr_b16 v[198:199], v229 offset:4096
    v_mfma_f32_16x16x32_bf16 v[136:139], v[200:203], v[44:47], v[136:139]
    ds_read_b128 v[8:11], v251 offset:4096
    ds_read_b128 v[12:15], v252 offset:0
    v_mov_b32 v50, 0
    s_waitcnt lgkmcnt(15)
    v_mfma_f32_16x16x32_bf16 v[124:127], v[204:207], v[36:39], v[124:127]
    ds_read_b64_tr_b16 v[200:201], v230 offset:0
    v_mfma_f32_16x16x32_bf16 v[132:135], v[204:207], v[40:43], v[132:135]
    ds_read_b64_tr_b16 v[202:203], v230 offset:4096
    v_mfma_f32_16x16x32_bf16 v[140:143], v[204:207], v[44:47], v[140:143]
    ds_read_b128 v[16:19], v252 offset:2048
    ds_read_b128 v[20:23], v252 offset:4096
    v_mov_b32 v51, 0
    s_waitcnt lgkmcnt(15)
    v_mfma_f32_16x16x32_bf16 v[144:147], v[208:211], v[36:39], v[144:147]
    ds_read_b64_tr_b16 v[204:205], v231 offset:0
    v_mfma_f32_16x16x32_bf16 v[152:155], v[208:211], v[40:43], v[152:155]
    ds_read_b64_tr_b16 v[206:207], v231 offset:4096
    v_mfma_f32_16x16x32_bf16 v[160:163], v[208:211], v[44:47], v[160:163]
    v_mov_b32 v52, 0
    v_mfma_f32_16x16x32_bf16 v[148:151], v[212:215], v[36:39], v[148:151]
    ds_read_b64_tr_b16 v[208:209], v232 offset:0
    v_mfma_f32_16x16x32_bf16 v[156:159], v[212:215], v[40:43], v[156:159]
    ds_read_b64_tr_b16 v[210:211], v232 offset:4096
    v_mfma_f32_16x16x32_bf16 v[164:167], v[212:215], v[44:47], v[164:167]
    v_mov_b32 v53, 0
    s_waitcnt lgkmcnt(15)
    v_mfma_f32_16x16x32_bf16 v[168:171], v[216:219], v[36:39], v[168:171]
    ds_read_b64_tr_b16 v[212:213], v233 offset:0
    v_mfma_f32_16x16x32_bf16 v[176:179], v[216:219], v[40:43], v[176:179]
    ds_read_b64_tr_b16 v[214:215], v233 offset:4096
    v_mfma_f32_16x16x32_bf16 v[184:187], v[216:219], v[44:47], v[184:187]
    v_mov_b32 v54, 0
    v_mfma_f32_16x16x32_bf16 v[172:175], v[220:223], v[36:39], v[172:175]
    ds_read_b64_tr_b16 v[216:217], v234 offset:0
    v_mfma_f32_16x16x32_bf16 v[180:183], v[220:223], v[40:43], v[180:183]
    ds_read_b64_tr_b16 v[218:219], v234 offset:4096
    v_mfma_f32_16x16x32_bf16 v[188:191], v[220:223], v[44:47], v[188:191]
    v_mov_b32 v55, 0
    s_waitcnt lgkmcnt(13)
    v_mfma_f32_16x16x32_bf16 v[96:99], v[192:195], v[0:3], v[96:99]
    ds_read_b64_tr_b16 v[220:221], v235 offset:0
    v_mfma_f32_16x16x32_bf16 v[104:107], v[192:195], v[4:7], v[104:107]
    ds_read_b64_tr_b16 v[222:223], v235 offset:4096
    v_mfma_f32_16x16x32_bf16 v[112:115], v[192:195], v[8:11], v[112:115]
    v_mov_b32 v56, 0
    s_waitcnt lgkmcnt(10)
    s_barrier
    v_mfma_f32_16x16x32_bf16 v[100:103], v[196:199], v[0:3], v[100:103]
    ds_read_b64_tr_b16 v[192:193], v228 offset:16384
    v_mfma_f32_16x16x32_bf16 v[108:111], v[196:199], v[4:7], v[108:111]
    ds_read_b64_tr_b16 v[194:195], v228 offset:20480
    v_mfma_f32_16x16x32_bf16 v[116:119], v[196:199], v[8:11], v[116:119]
    v_mov_b32 v57, 0
    v_mfma_f32_16x16x32_bf16 v[120:123], v[200:203], v[0:3], v[120:123]
    ds_read_b64_tr_b16 v[196:197], v229 offset:16384
    v_mfma_f32_16x16x32_bf16 v[128:131], v[200:203], v[4:7], v[128:131]
    ds_read_b64_tr_b16 v[198:199], v229 offset:20480
    v_mfma_f32_16x16x32_bf16 v[136:139], v[200:203], v[8:11], v[136:139]
    s_lshr_b32 s7, 1, s89
    s_bitcmp1_b32 s7, 0
    s_cbranch_scc0 L_KVS34
    s_add_u32 m0, s79, 0
    s_mov_b32 s76, 0
    buffer_load_dwordx4 v255, s[40:43], s76 offen nt lds
    s_add_u32 m0, s79, 4096
    s_mov_b32 s76, 4096
    buffer_load_dwordx4 v255, s[40:43], s76 offen nt lds
    s_add_u32 m0, s79, 8192
    s_mov_b32 s76, 8192
    buffer_load_dwordx4 v255, s[40:43], s76 offen nt lds
    s_add_u32 m0, s79, 12288
    s_mov_b32 s76, 12288
    buffer_load_dwordx4 v255, s[40:43], s76 offen nt lds
    s_add_u32 m0, s79, 16384
    s_mov_b32 s76, 131072
    buffer_load_dwordx4 v255, s[40:43], s76 offen nt lds
    s_add_u32 m0, s79, 20480
    s_mov_b32 s76, 135168
    buffer_load_dwordx4 v255, s[40:43], s76 offen nt lds
    s_add_u32 m0, s79, 24576
    s_mov_b32 s76, 139264
    buffer_load_dwordx4 v255, s[40:43], s76 offen nt lds
    s_add_u32 m0, s79, 28672
    s_mov_b32 s76, 143360
    buffer_load_dwordx4 v255, s[40:43], s76 offen nt lds
    s_add_u32 m0, s79, 32768
    s_mov_b32 s76, 0
    buffer_load_dwordx4 v255, s[44:47], s76 offen nt lds
    s_add_u32 m0, s79, 36864
    s_mov_b32 s76, 4096
    buffer_load_dwordx4 v255, s[44:47], s76 offen nt lds
    s_add_u32 m0, s79, 40960
    s_mov_b32 s76, 8192
    buffer_load_dwordx4 v255, s[44:47], s76 offen nt lds
    s_add_u32 m0, s79, 45056
    s_mov_b32 s76, 12288
    buffer_load_dwordx4 v255, s[44:47], s76 offen nt lds
    s_add_u32 m0, s79, 49152
    s_mov_b32 s76, 131072
    buffer_load_dwordx4 v255, s[44:47], s76 offen nt lds
    s_add_u32 m0, s79, 53248
    s_mov_b32 s76, 135168
    buffer_load_dwordx4 v255, s[44:47], s76 offen nt lds
    s_add_u32 m0, s79, 57344
    s_mov_b32 s76, 139264
    buffer_load_dwordx4 v255, s[44:47], s76 offen nt lds
    s_add_u32 m0, s79, 61440
    s_mov_b32 s76, 143360
    buffer_load_dwordx4 v255, s[44:47], s76 offen nt lds
L_KVS34:
    v_mov_b32 v58, 0
    s_waitcnt lgkmcnt(12)
    v_mfma_f32_16x16x32_bf16 v[124:127], v[204:207], v[0:3], v[124:127]
    ds_read_b64_tr_b16 v[200:201], v230 offset:16384
    v_mfma_f32_16x16x32_bf16 v[132:135], v[204:207], v[4:7], v[132:135]
    ds_read_b64_tr_b16 v[202:203], v230 offset:20480
    v_mfma_f32_16x16x32_bf16 v[140:143], v[204:207], v[8:11], v[140:143]
    v_mov_b32 v59, 0
    s_waitcnt lgkmcnt(12)
    v_mfma_f32_16x16x32_bf16 v[144:147], v[208:211], v[0:3], v[144:147]
    ds_read_b64_tr_b16 v[204:205], v231 offset:16384
    v_mfma_f32_16x16x32_bf16 v[152:155], v[208:211], v[4:7], v[152:155]
    ds_read_b64_tr_b16 v[206:207], v231 offset:20480
    v_mfma_f32_16x16x32_bf16 v[160:163], v[208:211], v[8:11], v[160:163]
    v_mov_b32 v60, 0
    s_waitcnt lgkmcnt(12)
    v_mfma_f32_16x16x32_bf16 v[148:151], v[212:215], v[0:3], v[148:151]
    ds_read_b64_tr_b16 v[208:209], v232 offset:16384
    v_mfma_f32_16x16x32_bf16 v[156:159], v[212:215], v[4:7], v[156:159]
    ds_read_b64_tr_b16 v[210:211], v232 offset:20480
    v_mfma_f32_16x16x32_bf16 v[164:167], v[212:215], v[8:11], v[164:167]
    v_mov_b32 v61, 0
    s_waitcnt lgkmcnt(12)
    v_mfma_f32_16x16x32_bf16 v[168:171], v[216:219], v[0:3], v[168:171]
    ds_read_b64_tr_b16 v[212:213], v233 offset:16384
    v_mfma_f32_16x16x32_bf16 v[176:179], v[216:219], v[4:7], v[176:179]
    ds_read_b64_tr_b16 v[214:215], v233 offset:20480
    v_mfma_f32_16x16x32_bf16 v[184:187], v[216:219], v[8:11], v[184:187]
    v_mov_b32 v62, 0
    s_waitcnt lgkmcnt(12)
    v_mfma_f32_16x16x32_bf16 v[172:175], v[220:223], v[0:3], v[172:175]
    ds_read_b64_tr_b16 v[216:217], v234 offset:16384
    v_mfma_f32_16x16x32_bf16 v[180:183], v[220:223], v[4:7], v[180:183]
    ds_read_b64_tr_b16 v[218:219], v234 offset:20480
    v_mfma_f32_16x16x32_bf16 v[188:191], v[220:223], v[8:11], v[188:191]
    v_mov_b32 v63, 0
    s_waitcnt lgkmcnt(12)
    v_mfma_f32_16x16x32_bf16 v[96:99], v[192:195], v[12:15], v[96:99]
    ds_read_b64_tr_b16 v[220:221], v235 offset:16384
    v_mfma_f32_16x16x32_bf16 v[104:107], v[192:195], v[16:19], v[104:107]
    ds_read_b64_tr_b16 v[222:223], v235 offset:20480
    v_mfma_f32_16x16x32_bf16 v[112:115], v[192:195], v[20:23], v[112:115]
    v_mov_b32 v64, 0
    s_waitcnt lgkmcnt(12)
    s_barrier
    v_mfma_f32_16x16x32_bf16 v[100:103], v[196:199], v[12:15], v[100:103]
    ds_read_b64_tr_b16 v[192:193], v228 offset:32768
    v_mfma_f32_16x16x32_bf16 v[108:111], v[196:199], v[16:19], v[108:111]
    ds_read_b64_tr_b16 v[194:195], v228 offset:36864
    v_mfma_f32_16x16x32_bf16 v[116:119], v[196:199], v[20:23], v[116:119]
    ds_read_b128 v[24:27], v251 offset:12288
    ds_read_b128 v[28:31], v251 offset:14336
    v_mov_b32 v65, 0
    s_waitcnt lgkmcnt(14)
    v_mfma_f32_16x16x32_bf16 v[120:123], v[200:203], v[12:15], v[120:123]
    ds_read_b64_tr_b16 v[196:197], v229 offset:32768
    v_mfma_f32_16x16x32_bf16 v[128:131], v[200:203], v[16:19], v[128:131]
    ds_read_b64_tr_b16 v[198:199], v229 offset:36864
    v_mfma_f32_16x16x32_bf16 v[136:139], v[200:203], v[20:23], v[136:139]
    ds_read_b128 v[32:35], v251 offset:16384
    ds_read_b128 v[36:39], v252 offset:12288
    s_lshr_b32 s7, 2, s89
    s_bitcmp1_b32 s7, 0
    s_cbranch_scc0 L_KVS42
    s_add_u32 m0, s79, 0
    s_mov_b32 s76, 0
    buffer_load_dwordx4 v255, s[40:43], s76 offen nt lds
    s_add_u32 m0, s79, 4096
    s_mov_b32 s76, 4096
    buffer_load_dwordx4 v255, s[40:43], s76 offen nt lds
    s_add_u32 m0, s79, 8192
    s_mov_b32 s76, 8192
    buffer_load_dwordx4 v255, s[40:43], s76 offen nt lds
    s_add_u32 m0, s79, 12288
    s_mov_b32 s76, 12288
    buffer_load_dwordx4 v255, s[40:43], s76 offen nt lds
    s_add_u32 m0, s79, 16384
    s_mov_b32 s76, 131072
    buffer_load_dwordx4 v255, s[40:43], s76 offen nt lds
    s_add_u32 m0, s79, 20480
    s_mov_b32 s76, 135168
    buffer_load_dwordx4 v255, s[40:43], s76 offen nt lds
    s_add_u32 m0, s79, 24576
    s_mov_b32 s76, 139264
    buffer_load_dwordx4 v255, s[40:43], s76 offen nt lds
    s_add_u32 m0, s79, 28672
    s_mov_b32 s76, 143360
    buffer_load_dwordx4 v255, s[40:43], s76 offen nt lds
    s_add_u32 m0, s79, 32768
    s_mov_b32 s76, 0
    buffer_load_dwordx4 v255, s[44:47], s76 offen nt lds
    s_add_u32 m0, s79, 36864
    s_mov_b32 s76, 4096
    buffer_load_dwordx4 v255, s[44:47], s76 offen nt lds
    s_add_u32 m0, s79, 40960
    s_mov_b32 s76, 8192
    buffer_load_dwordx4 v255, s[44:47], s76 offen nt lds
    s_add_u32 m0, s79, 45056
    s_mov_b32 s76, 12288
    buffer_load_dwordx4 v255, s[44:47], s76 offen nt lds
    s_add_u32 m0, s79, 49152
    s_mov_b32 s76, 131072
    buffer_load_dwordx4 v255, s[44:47], s76 offen nt lds
    s_add_u32 m0, s79, 53248
    s_mov_b32 s76, 135168
    buffer_load_dwordx4 v255, s[44:47], s76 offen nt lds
    s_add_u32 m0, s79, 57344
    s_mov_b32 s76, 139264
    buffer_load_dwordx4 v255, s[44:47], s76 offen nt lds
    s_add_u32 m0, s79, 61440
    s_mov_b32 s76, 143360
    buffer_load_dwordx4 v255, s[44:47], s76 offen nt lds
L_KVS42:
    v_mov_b32 v66, 0
    s_waitcnt lgkmcnt(15)
    v_mfma_f32_16x16x32_bf16 v[124:127], v[204:207], v[12:15], v[124:127]
    ds_read_b64_tr_b16 v[200:201], v230 offset:32768
    v_mfma_f32_16x16x32_bf16 v[132:135], v[204:207], v[16:19], v[132:135]
    ds_read_b64_tr_b16 v[202:203], v230 offset:36864
    v_mfma_f32_16x16x32_bf16 v[140:143], v[204:207], v[20:23], v[140:143]
    ds_read_b128 v[40:43], v252 offset:14336
    ds_read_b128 v[44:47], v252 offset:16384
    v_mov_b32 v67, 0
    s_waitcnt lgkmcnt(15)
    v_mfma_f32_16x16x32_bf16 v[144:147], v[208:211], v[12:15], v[144:147]
    ds_read_b64_tr_b16 v[204:205], v231 offset:32768
    v_mfma_f32_16x16x32_bf16 v[152:155], v[208:211], v[16:19], v[152:155]
    ds_read_b64_tr_b16 v[206:207], v231 offset:36864
    v_mfma_f32_16x16x32_bf16 v[160:163], v[208:211], v[20:23], v[160:163]
    v_mov_b32 v68, 0
    v_mfma_f32_16x16x32_bf16 v[148:151], v[212:215], v[12:15], v[148:151]
    ds_read_b64_tr_b16 v[208:209], v232 offset:32768
    v_mfma_f32_16x16x32_bf16 v[156:159], v[212:215], v[16:19], v[156:159]
    ds_read_b64_tr_b16 v[210:211], v232 offset:36864
    v_mfma_f32_16x16x32_bf16 v[164:167], v[212:215], v[20:23], v[164:167]
    v_mov_b32 v69, 0
    s_waitcnt lgkmcnt(15)
    v_mfma_f32_16x16x32_bf16 v[168:171], v[216:219], v[12:15], v[168:171]
    ds_read_b64_tr_b16 v[212:213], v233 offset:32768
    v_mfma_f32_16x16x32_bf16 v[176:179], v[216:219], v[16:19], v[176:179]
    ds_read_b64_tr_b16 v[214:215], v233 offset:36864
    v_mfma_f32_16x16x32_bf16 v[184:187], v[216:219], v[20:23], v[184:187]
    v_mov_b32 v70, 0
    v_mfma_f32_16x16x32_bf16 v[172:175], v[220:223], v[12:15], v[172:175]
    ds_read_b64_tr_b16 v[216:217], v234 offset:32768
    v_mfma_f32_16x16x32_bf16 v[180:183], v[220:223], v[16:19], v[180:183]
    ds_read_b64_tr_b16 v[218:219], v234 offset:36864
    v_mfma_f32_16x16x32_bf16 v[188:191], v[220:223], v[20:23], v[188:191]
    v_mov_b32 v71, 0
    s_waitcnt lgkmcnt(13)
    v_mfma_f32_16x16x32_bf16 v[96:99], v[192:195], v[24:27], v[96:99]
    ds_read_b64_tr_b16 v[220:221], v235 offset:32768
    v_mfma_f32_16x16x32_bf16 v[104:107], v[192:195], v[28:31], v[104:107]
    ds_read_b64_tr_b16 v[222:223], v235 offset:36864
    v_mfma_f32_16x16x32_bf16 v[112:115], v[192:195], v[32:35], v[112:115]
    v_mov_b32 v72, 0
    s_waitcnt lgkmcnt(10)
    s_barrier
    v_mfma_f32_16x16x32_bf16 v[100:103], v[196:199], v[24:27], v[100:103]
    ds_read_b64_tr_b16 v[192:193], v228 offset:49152
    v_mfma_f32_16x16x32_bf16 v[108:111], v[196:199], v[28:31], v[108:111]
    ds_read_b64_tr_b16 v[194:195], v228 offset:53248
    v_mfma_f32_16x16x32_bf16 v[116:119], v[196:199], v[32:35], v[116:119]
    v_mov_b32 v73, 0
    v_mfma_f32_16x16x32_bf16 v[120:123], v[200:203], v[24:27], v[120:123]
    ds_read_b64_tr_b16 v[196:197], v229 offset:49152
    v_mfma_f32_16x16x32_bf16 v[128:131], v[200:203], v[28:31], v[128:131]
    ds_read_b64_tr_b16 v[198:199], v229 offset:53248
    v_mfma_f32_16x16x32_bf16 v[136:139], v[200:203], v[32:35], v[136:139]
    s_lshr_b32 s7, 4, s89
    s_bitcmp1_b32 s7, 0
    s_cbranch_scc0 L_KVS50
    s_add_u32 m0, s79, 0
    s_mov_b32 s76, 0
    buffer_load_dwordx4 v255, s[40:43], s76 offen nt lds
    s_add_u32 m0, s79, 4096
    s_mov_b32 s76, 4096
    buffer_load_dwordx4 v255, s[40:43], s76 offen nt lds
    s_add_u32 m0, s79, 8192
    s_mov_b32 s76, 8192
    buffer_load_dwordx4 v255, s[40:43], s76 offen nt lds
    s_add_u32 m0, s79, 12288
    s_mov_b32 s76, 12288
    buffer_load_dwordx4 v255, s[40:43], s76 offen nt lds
    s_add_u32 m0, s79, 16384
    s_mov_b32 s76, 131072
    buffer_load_dwordx4 v255, s[40:43], s76 offen nt lds
    s_add_u32 m0, s79, 20480
    s_mov_b32 s76, 135168
    buffer_load_dwordx4 v255, s[40:43], s76 offen nt lds
    s_add_u32 m0, s79, 24576
    s_mov_b32 s76, 139264
    buffer_load_dwordx4 v255, s[40:43], s76 offen nt lds
    s_add_u32 m0, s79, 28672
    s_mov_b32 s76, 143360
    buffer_load_dwordx4 v255, s[40:43], s76 offen nt lds
    s_add_u32 m0, s79, 32768
    s_mov_b32 s76, 0
    buffer_load_dwordx4 v255, s[44:47], s76 offen nt lds
    s_add_u32 m0, s79, 36864
    s_mov_b32 s76, 4096
    buffer_load_dwordx4 v255, s[44:47], s76 offen nt lds
    s_add_u32 m0, s79, 40960
    s_mov_b32 s76, 8192
    buffer_load_dwordx4 v255, s[44:47], s76 offen nt lds
    s_add_u32 m0, s79, 45056
    s_mov_b32 s76, 12288
    buffer_load_dwordx4 v255, s[44:47], s76 offen nt lds
    s_add_u32 m0, s79, 49152
    s_mov_b32 s76, 131072
    buffer_load_dwordx4 v255, s[44:47], s76 offen nt lds
    s_add_u32 m0, s79, 53248
    s_mov_b32 s76, 135168
    buffer_load_dwordx4 v255, s[44:47], s76 offen nt lds
    s_add_u32 m0, s79, 57344
    s_mov_b32 s76, 139264
    buffer_load_dwordx4 v255, s[44:47], s76 offen nt lds
    s_add_u32 m0, s79, 61440
    s_mov_b32 s76, 143360
    buffer_load_dwordx4 v255, s[44:47], s76 offen nt lds
L_KVS50:
    v_mov_b32 v74, 0
    s_waitcnt lgkmcnt(12)
    v_mfma_f32_16x16x32_bf16 v[124:127], v[204:207], v[24:27], v[124:127]
    ds_read_b64_tr_b16 v[200:201], v230 offset:49152
    v_mfma_f32_16x16x32_bf16 v[132:135], v[204:207], v[28:31], v[132:135]
    ds_read_b64_tr_b16 v[202:203], v230 offset:53248
    v_mfma_f32_16x16x32_bf16 v[140:143], v[204:207], v[32:35], v[140:143]
    v_mov_b32 v75, 0
    s_waitcnt lgkmcnt(12)
    v_mfma_f32_16x16x32_bf16 v[144:147], v[208:211], v[24:27], v[144:147]
    ds_read_b64_tr_b16 v[204:205], v231 offset:49152
    v_mfma_f32_16x16x32_bf16 v[152:155], v[208:211], v[28:31], v[152:155]
    ds_read_b64_tr_b16 v[206:207], v231 offset:53248
    v_mfma_f32_16x16x32_bf16 v[160:163], v[208:211], v[32:35], v[160:163]
    v_mov_b32 v76, 0
    s_waitcnt lgkmcnt(12)
    v_mfma_f32_16x16x32_bf16 v[148:151], v[212:215], v[24:27], v[148:151]
    ds_read_b64_tr_b16 v[208:209], v232 offset:49152
    v_mfma_f32_16x16x32_bf16 v[156:159], v[212:215], v[28:31], v[156:159]
    ds_read_b64_tr_b16 v[210:211], v232 offset:53248
    v_mfma_f32_16x16x32_bf16 v[164:167], v[212:215], v[32:35], v[164:167]
    v_mov_b32 v77, 0
    s_waitcnt lgkmcnt(12)
    v_mfma_f32_16x16x32_bf16 v[168:171], v[216:219], v[24:27], v[168:171]
    ds_read_b64_tr_b16 v[212:213], v233 offset:49152
    v_mfma_f32_16x16x32_bf16 v[176:179], v[216:219], v[28:31], v[176:179]
    ds_read_b64_tr_b16 v[214:215], v233 offset:53248
    v_mfma_f32_16x16x32_bf16 v[184:187], v[216:219], v[32:35], v[184:187]
    v_mov_b32 v78, 0
    s_waitcnt lgkmcnt(12)
    v_mfma_f32_16x16x32_bf16 v[172:175], v[220:223], v[24:27], v[172:175]
    ds_read_b64_tr_b16 v[216:217], v234 offset:49152
    v_mfma_f32_16x16x32_bf16 v[180:183], v[220:223], v[28:31], v[180:183]
    ds_read_b64_tr_b16 v[218:219], v234 offset:53248
    v_mfma_f32_16x16x32_bf16 v[188:191], v[220:223], v[32:35], v[188:191]
    v_mov_b32 v79, 0
    s_waitcnt lgkmcnt(12)
    v_mfma_f32_16x16x32_bf16 v[96:99], v[192:195], v[36:39], v[96:99]
    ds_read_b64_tr_b16 v[220:221], v235 offset:49152
    v_mfma_f32_16x16x32_bf16 v[104:107], v[192:195], v[40:43], v[104:107]
    ds_read_b64_tr_b16 v[222:223], v235 offset:53248
    v_mfma_f32_16x16x32_bf16 v[112:115], v[192:195], v[44:47], v[112:115]
    v_mov_b32 v80, 0
    s_waitcnt lgkmcnt(12)
    s_barrier
    v_mfma_f32_16x16x32_bf16 v[100:103], v[196:199], v[36:39], v[100:103]
    ds_read_b64_tr_b16 v[192:193], v228 offset:0
    v_mfma_f32_16x16x32_bf16 v[108:111], v[196:199], v[40:43], v[108:111]
    ds_read_b64_tr_b16 v[194:195], v228 offset:4096
    v_mfma_f32_16x16x32_bf16 v[116:119], v[196:199], v[44:47], v[116:119]
    ds_read_b128 v[0:3], v251 offset:0
    ds_read_b128 v[4:7], v251 offset:2048
    v_mov_b32 v81, 0
    s_waitcnt lgkmcnt(14)
    v_mfma_f32_16x16x32_bf16 v[120:123], v[200:203], v[36:39], v[120:123]
    ds_read_b64_tr_b16 v[196:197], v229 offset:0
    v_mfma_f32_16x16x32_bf16 v[128:131], v[200:203], v[40:43], v[128:131]
    ds_read_b64_tr_b16 v[198:199], v229 offset:4096
    v_mfma_f32_16x16x32_bf16 v[136:139], v[200:203], v[44:47], v[136:139]
    ds_read_b128 v[8:11], v251 offset:4096
    ds_read_b128 v[12:15], v252 offset:0
    s_lshr_b32 s7, 8, s89
    s_bitcmp1_b32 s7, 0
    s_cbranch_scc0 L_KVS58
    s_add_u32 m0, s79, 0
    s_mov_b32 s76, 0
    buffer_load_dwordx4 v255, s[40:43], s76 offen nt lds
    s_add_u32 m0, s79, 4096
    s_mov_b32 s76, 4096
    buffer_load_dwordx4 v255, s[40:43], s76 offen nt lds
    s_add_u32 m0, s79, 8192
    s_mov_b32 s76, 8192
    buffer_load_dwordx4 v255, s[40:43], s76 offen nt lds
    s_add_u32 m0, s79, 12288
    s_mov_b32 s76, 12288
    buffer_load_dwordx4 v255, s[40:43], s76 offen nt lds
    s_add_u32 m0, s79, 16384
    s_mov_b32 s76, 131072
    buffer_load_dwordx4 v255, s[40:43], s76 offen nt lds
    s_add_u32 m0, s79, 20480
    s_mov_b32 s76, 135168
    buffer_load_dwordx4 v255, s[40:43], s76 offen nt lds
    s_add_u32 m0, s79, 24576
    s_mov_b32 s76, 139264
    buffer_load_dwordx4 v255, s[40:43], s76 offen nt lds
    s_add_u32 m0, s79, 28672
    s_mov_b32 s76, 143360
    buffer_load_dwordx4 v255, s[40:43], s76 offen nt lds
    s_add_u32 m0, s79, 32768
    s_mov_b32 s76, 0
    buffer_load_dwordx4 v255, s[44:47], s76 offen nt lds
    s_add_u32 m0, s79, 36864
    s_mov_b32 s76, 4096
    buffer_load_dwordx4 v255, s[44:47], s76 offen nt lds
    s_add_u32 m0, s79, 40960
    s_mov_b32 s76, 8192
    buffer_load_dwordx4 v255, s[44:47], s76 offen nt lds
    s_add_u32 m0, s79, 45056
    s_mov_b32 s76, 12288
    buffer_load_dwordx4 v255, s[44:47], s76 offen nt lds
    s_add_u32 m0, s79, 49152
    s_mov_b32 s76, 131072
    buffer_load_dwordx4 v255, s[44:47], s76 offen nt lds
    s_add_u32 m0, s79, 53248
    s_mov_b32 s76, 135168
    buffer_load_dwordx4 v255, s[44:47], s76 offen nt lds
    s_add_u32 m0, s79, 57344
    s_mov_b32 s76, 139264
    buffer_load_dwordx4 v255, s[44:47], s76 offen nt lds
    s_add_u32 m0, s79, 61440
    s_mov_b32 s76, 143360
    buffer_load_dwordx4 v255, s[44:47], s76 offen nt lds
L_KVS58:
    v_mov_b32 v82, 0
    s_waitcnt lgkmcnt(15)
    v_mfma_f32_16x16x32_bf16 v[124:127], v[204:207], v[36:39], v[124:127]
    ds_read_b64_tr_b16 v[200:201], v230 offset:0
    v_mfma_f32_16x16x32_bf16 v[132:135], v[204:207], v[40:43], v[132:135]
    ds_read_b64_tr_b16 v[202:203], v230 offset:4096
    v_mfma_f32_16x16x32_bf16 v[140:143], v[204:207], v[44:47], v[140:143]
    ds_read_b128 v[16:19], v252 offset:2048
    ds_read_b128 v[20:23], v252 offset:4096
    v_mov_b32 v83, 0
    s_waitcnt lgkmcnt(15)
    v_mfma_f32_16x16x32_bf16 v[144:147], v[208:211], v[36:39], v[144:147]
    ds_read_b64_tr_b16 v[204:205], v231 offset:0
    v_mfma_f32_16x16x32_bf16 v[152:155], v[208:211], v[40:43], v[152:155]
    ds_read_b64_tr_b16 v[206:207], v231 offset:4096
    v_mfma_f32_16x16x32_bf16 v[160:163], v[208:211], v[44:47], v[160:163]
    v_mov_b32 v84, 0
    v_mfma_f32_16x16x32_bf16 v[148:151], v[212:215], v[36:39], v[148:151]
    ds_read_b64_tr_b16 v[208:209], v232 offset:0
    v_mfma_f32_16x16x32_bf16 v[156:159], v[212:215], v[40:43], v[156:159]
    ds_read_b64_tr_b16 v[210:211], v232 offset:4096
    v_mfma_f32_16x16x32_bf16 v[164:167], v[212:215], v[44:47], v[164:167]
    v_mov_b32 v85, 0
    s_waitcnt lgkmcnt(15)
    v_mfma_f32_16x16x32_bf16 v[168:171], v[216:219], v[36:39], v[168:171]
    ds_read_b64_tr_b16 v[212:213], v233 offset:0
    v_mfma_f32_16x16x32_bf16 v[176:179], v[216:219], v[40:43], v[176:179]
    ds_read_b64_tr_b16 v[214:215], v233 offset:4096
    v_mfma_f32_16x16x32_bf16 v[184:187], v[216:219], v[44:47], v[184:187]
    v_mov_b32 v86, 0
    v_mfma_f32_16x16x32_bf16 v[172:175], v[220:223], v[36:39], v[172:175]
    ds_read_b64_tr_b16 v[216:217], v234 offset:0
    v_mfma_f32_16x16x32_bf16 v[180:183], v[220:223], v[40:43], v[180:183]
    ds_read_b64_tr_b16 v[218:219], v234 offset:4096
    v_mfma_f32_16x16x32_bf16 v[188:191], v[220:223], v[44:47], v[188:191]
    v_mov_b32 v87, 0
    s_waitcnt lgkmcnt(13)
    v_mfma_f32_16x16x32_bf16 v[96:99], v[192:195], v[0:3], v[96:99]
    ds_read_b64_tr_b16 v[220:221], v235 offset:0
    v_mfma_f32_16x16x32_bf16 v[104:107], v[192:195], v[4:7], v[104:107]
    ds_read_b64_tr_b16 v[222:223], v235 offset:4096
    v_mfma_f32_16x16x32_bf16 v[112:115], v[192:195], v[8:11], v[112:115]
    v_mov_b32 v88, 0
    s_waitcnt lgkmcnt(10)
    s_barrier
    v_mfma_f32_16x16x32_bf16 v[100:103], v[196:199], v[0:3], v[100:103]
    ds_read_b64_tr_b16 v[192:193], v228 offset:16384
    v_mfma_f32_16x16x32_bf16 v[108:111], v[196:199], v[4:7], v[108:111]
    ds_read_b64_tr_b16 v[194:195], v228 offset:20480
    v_mfma_f32_16x16x32_bf16 v[116:119], v[196:199], v[8:11], v[116:119]
    v_mov_b32 v89, 0
    v_mfma_f32_16x16x32_bf16 v[120:123], v[200:203], v[0:3], v[120:123]
    ds_read_b64_tr_b16 v[196:197], v229 offset:16384
    v_mfma_f32_16x16x32_bf16 v[128:131], v[200:203], v[4:7], v[128:131]
    ds_read_b64_tr_b16 v[198:199], v229 offset:20480
    v_mfma_f32_16x16x32_bf16 v[136:139], v[200:203], v[8:11], v[136:139]
    s_lshr_b32 s7, 16, s89
    s_bitcmp1_b32 s7, 0
    s_cbranch_scc0 L_KVS66
    s_add_u32 m0, s79, 0
    s_mov_b32 s76, 0
    buffer_load_dwordx4 v255, s[40:43], s76 offen nt lds
    s_add_u32 m0, s79, 4096
    s_mov_b32 s76, 4096
    buffer_load_dwordx4 v255, s[40:43], s76 offen nt lds
    s_add_u32 m0, s79, 8192
    s_mov_b32 s76, 8192
    buffer_load_dwordx4 v255, s[40:43], s76 offen nt lds
    s_add_u32 m0, s79, 12288
    s_mov_b32 s76, 12288
    buffer_load_dwordx4 v255, s[40:43], s76 offen nt lds
    s_add_u32 m0, s79, 16384
    s_mov_b32 s76, 131072
    buffer_load_dwordx4 v255, s[40:43], s76 offen nt lds
    s_add_u32 m0, s79, 20480
    s_mov_b32 s76, 135168
    buffer_load_dwordx4 v255, s[40:43], s76 offen nt lds
    s_add_u32 m0, s79, 24576
    s_mov_b32 s76, 139264
    buffer_load_dwordx4 v255, s[40:43], s76 offen nt lds
    s_add_u32 m0, s79, 28672
    s_mov_b32 s76, 143360
    buffer_load_dwordx4 v255, s[40:43], s76 offen nt lds
    s_add_u32 m0, s79, 32768
    s_mov_b32 s76, 0
    buffer_load_dwordx4 v255, s[44:47], s76 offen nt lds
    s_add_u32 m0, s79, 36864
    s_mov_b32 s76, 4096
    buffer_load_dwordx4 v255, s[44:47], s76 offen nt lds
    s_add_u32 m0, s79, 40960
    s_mov_b32 s76, 8192
    buffer_load_dwordx4 v255, s[44:47], s76 offen nt lds
    s_add_u32 m0, s79, 45056
    s_mov_b32 s76, 12288
    buffer_load_dwordx4 v255, s[44:47], s76 offen nt lds
    s_add_u32 m0, s79, 49152
    s_mov_b32 s76, 131072
    buffer_load_dwordx4 v255, s[44:47], s76 offen nt lds
    s_add_u32 m0, s79, 53248
    s_mov_b32 s76, 135168
    buffer_load_dwordx4 v255, s[44:47], s76 offen nt lds
    s_add_u32 m0, s79, 57344
    s_mov_b32 s76, 139264
    buffer_load_dwordx4 v255, s[44:47], s76 offen nt lds
    s_add_u32 m0, s79, 61440
    s_mov_b32 s76, 143360
    buffer_load_dwordx4 v255, s[44:47], s76 offen nt lds
L_KVS66:
    v_mov_b32 v90, 0
    s_waitcnt lgkmcnt(12)
    v_mfma_f32_16x16x32_bf16 v[124:127], v[204:207], v[0:3], v[124:127]
    ds_read_b64_tr_b16 v[200:201], v230 offset:16384
    v_mfma_f32_16x16x32_bf16 v[132:135], v[204:207], v[4:7], v[132:135]
    ds_read_b64_tr_b16 v[202:203], v230 offset:20480
    v_mfma_f32_16x16x32_bf16 v[140:143], v[204:207], v[8:11], v[140:143]
    v_mov_b32 v91, 0
    s_waitcnt lgkmcnt(12)
    v_mfma_f32_16x16x32_bf16 v[144:147], v[208:211], v[0:3], v[144:147]
    ds_read_b64_tr_b16 v[204:205], v231 offset:16384
    v_mfma_f32_16x16x32_bf16 v[152:155], v[208:211], v[4:7], v[152:155]
    ds_read_b64_tr_b16 v[206:207], v231 offset:20480
    v_mfma_f32_16x16x32_bf16 v[160:163], v[208:211], v[8:11], v[160:163]
    v_mov_b32 v92, 0
    s_waitcnt lgkmcnt(12)
    v_mfma_f32_16x16x32_bf16 v[148:151], v[212:215], v[0:3], v[148:151]
    ds_read_b64_tr_b16 v[208:209], v232 offset:16384
    v_mfma_f32_16x16x32_bf16 v[156:159], v[212:215], v[4:7], v[156:159]
    ds_read_b64_tr_b16 v[210:211], v232 offset:20480
    v_mfma_f32_16x16x32_bf16 v[164:167], v[212:215], v[8:11], v[164:167]
    v_mov_b32 v93, 0
    s_waitcnt lgkmcnt(12)
    v_mfma_f32_16x16x32_bf16 v[168:171], v[216:219], v[0:3], v[168:171]
    ds_read_b64_tr_b16 v[212:213], v233 offset:16384
    v_mfma_f32_16x16x32_bf16 v[176:179], v[216:219], v[4:7], v[176:179]
    ds_read_b64_tr_b16 v[214:215], v233 offset:20480
    v_mfma_f32_16x16x32_bf16 v[184:187], v[216:219], v[8:11], v[184:187]
    v_mov_b32 v94, 0
    s_waitcnt lgkmcnt(12)
    v_mfma_f32_16x16x32_bf16 v[172:175], v[220:223], v[0:3], v[172:175]
    ds_read_b64_tr_b16 v[216:217], v234 offset:16384
    v_mfma_f32_16x16x32_bf16 v[180:183], v[220:223], v[4:7], v[180:183]
    ds_read_b64_tr_b16 v[218:219], v234 offset:20480
    v_mfma_f32_16x16x32_bf16 v[188:191], v[220:223], v[8:11], v[188:191]
    v_mov_b32 v95, 0
    s_waitcnt lgkmcnt(12)
    v_mfma_f32_16x16x32_bf16 v[96:99], v[192:195], v[12:15], v[96:99]
    ds_read_b64_tr_b16 v[220:221], v235 offset:16384
    v_mfma_f32_16x16x32_bf16 v[104:107], v[192:195], v[16:19], v[104:107]
    ds_read_b64_tr_b16 v[222:223], v235 offset:20480
    v_mfma_f32_16x16x32_bf16 v[112:115], v[192:195], v[20:23], v[112:115]
    s_waitcnt lgkmcnt(12)
    s_barrier
    v_mfma_f32_16x16x32_bf16 v[100:103], v[196:199], v[12:15], v[100:103]
    ds_read_b64_tr_b16 v[192:193], v228 offset:32768
    v_mfma_f32_16x16x32_bf16 v[108:111], v[196:199], v[16:19], v[108:111]
    ds_read_b64_tr_b16 v[194:195], v228 offset:36864
    v_mfma_f32_16x16x32_bf16 v[116:119], v[196:199], v[20:23], v[116:119]
    ds_read_b128 v[24:27], v251 offset:12288
    ds_read_b128 v[28:31], v251 offset:14336
    s_waitcnt lgkmcnt(14)
    v_mfma_f32_16x16x32_bf16 v[120:123], v[200:203], v[12:15], v[120:123]
    ds_read_b64_tr_b16 v[196:197], v229 offset:32768
    v_mfma_f32_16x16x32_bf16 v[128:131], v[200:203], v[16:19], v[128:131]
    ds_read_b64_tr_b16 v[198:199], v229 offset:36864
    v_mfma_f32_16x16x32_bf16 v[136:139], v[200:203], v[20:23], v[136:139]
    ds_read_b128 v[32:35], v251 offset:16384
    ds_read_b128 v[36:39], v252 offset:12288
    s_lshr_b32 s7, 32, s89
    s_bitcmp1_b32 s7, 0
    s_cbranch_scc0 L_KVS74
    s_add_u32 m0, s79, 0
    s_mov_b32 s76, 0
    buffer_load_dwordx4 v255, s[40:43], s76 offen nt lds
    s_add_u32 m0, s79, 4096
    s_mov_b32 s76, 4096
    buffer_load_dwordx4 v255, s[40:43], s76 offen nt lds
    s_add_u32 m0, s79, 8192
    s_mov_b32 s76, 8192
    buffer_load_dwordx4 v255, s[40:43], s76 offen nt lds
    s_add_u32 m0, s79, 12288
    s_mov_b32 s76, 12288
    buffer_load_dwordx4 v255, s[40:43], s76 offen nt lds
    s_add_u32 m0, s79, 16384
    s_mov_b32 s76, 131072
    buffer_load_dwordx4 v255, s[40:43], s76 offen nt lds
    s_add_u32 m0, s79, 20480
    s_mov_b32 s76, 135168
    buffer_load_dwordx4 v255, s[40:43], s76 offen nt lds
    s_add_u32 m0, s79, 24576
    s_mov_b32 s76, 139264
    buffer_load_dwordx4 v255, s[40:43], s76 offen nt lds
    s_add_u32 m0, s79, 28672
    s_mov_b32 s76, 143360
    buffer_load_dwordx4 v255, s[40:43], s76 offen nt lds
    s_add_u32 m0, s79, 32768
    s_mov_b32 s76, 0
    buffer_load_dwordx4 v255, s[44:47], s76 offen nt lds
    s_add_u32 m0, s79, 36864
    s_mov_b32 s76, 4096
    buffer_load_dwordx4 v255, s[44:47], s76 offen nt lds
    s_add_u32 m0, s79, 40960
    s_mov_b32 s76, 8192
    buffer_load_dwordx4 v255, s[44:47], s76 offen nt lds
    s_add_u32 m0, s79, 45056
    s_mov_b32 s76, 12288
    buffer_load_dwordx4 v255, s[44:47], s76 offen nt lds
    s_add_u32 m0, s79, 49152
    s_mov_b32 s76, 131072
    buffer_load_dwordx4 v255, s[44:47], s76 offen nt lds
    s_add_u32 m0, s79, 53248
    s_mov_b32 s76, 135168
    buffer_load_dwordx4 v255, s[44:47], s76 offen nt lds
    s_add_u32 m0, s79, 57344
    s_mov_b32 s76, 139264
    buffer_load_dwordx4 v255, s[44:47], s76 offen nt lds
    s_add_u32 m0, s79, 61440
    s_mov_b32 s76, 143360
    buffer_load_dwordx4 v255, s[44:47], s76 offen nt lds
L_KVS74:
    s_waitcnt lgkmcnt(15)
    v_mfma_f32_16x16x32_bf16 v[124:127], v[204:207], v[12:15], v[124:127]
    ds_read_b64_tr_b16 v[200:201], v230 offset:32768
    v_mfma_f32_16x16x32_bf16 v[132:135], v[204:207], v[16:19], v[132:135]
    ds_read_b64_tr_b16 v[202:203], v230 offset:36864
    v_mfma_f32_16x16x32_bf16 v[140:143], v[204:207], v[20:23], v[140:143]
    ds_read_b128 v[40:43], v252 offset:14336
    ds_read_b128 v[44:47], v252 offset:16384
    s_waitcnt lgkmcnt(15)
    v_mfma_f32_16x16x32_bf16 v[144:147], v[208:211], v[12:15], v[144:147]
    ds_read_b64_tr_b16 v[204:205], v231 offset:32768
    v_mfma_f32_16x16x32_bf16 v[152:155], v[208:211], v[16:19], v[152:155]
    ds_read_b64_tr_b16 v[206:207], v231 offset:36864
    v_mfma_f32_16x16x32_bf16 v[160:163], v[208:211], v[20:23], v[160:163]
    v_mfma_f32_16x16x32_bf16 v[148:151], v[212:215], v[12:15], v[148:151]
    ds_read_b64_tr_b16 v[208:209], v232 offset:32768
    v_mfma_f32_16x16x32_bf16 v[156:159], v[212:215], v[16:19], v[156:159]
    ds_read_b64_tr_b16 v[210:211], v232 offset:36864
    v_mfma_f32_16x16x32_bf16 v[164:167], v[212:215], v[20:23], v[164:167]
    s_waitcnt lgkmcnt(15)
    v_mfma_f32_16x16x32_bf16 v[168:171], v[216:219], v[12:15], v[168:171]
    ds_read_b64_tr_b16 v[212:213], v233 offset:32768
    v_mfma_f32_16x16x32_bf16 v[176:179], v[216:219], v[16:19], v[176:179]
    ds_read_b64_tr_b16 v[214:215], v233 offset:36864
    v_mfma_f32_16x16x32_bf16 v[184:187], v[216:219], v[20:23], v[184:187]
    v_mfma_f32_16x16x32_bf16 v[172:175], v[220:223], v[12:15], v[172:175]
    ds_read_b64_tr_b16 v[216:217], v234 offset:32768
    v_mfma_f32_16x16x32_bf16 v[180:183], v[220:223], v[16:19], v[180:183]
    ds_read_b64_tr_b16 v[218:219], v234 offset:36864
    v_mfma_f32_16x16x32_bf16 v[188:191], v[220:223], v[20:23], v[188:191]
    s_waitcnt lgkmcnt(13)
    v_mfma_f32_16x16x32_bf16 v[96:99], v[192:195], v[24:27], v[96:99]
    ds_read_b64_tr_b16 v[220:221], v235 offset:32768
    v_mfma_f32_16x16x32_bf16 v[104:107], v[192:195], v[28:31], v[104:107]
    ds_read_b64_tr_b16 v[222:223], v235 offset:36864
    v_mfma_f32_16x16x32_bf16 v[112:115], v[192:195], v[32:35], v[112:115]
    s_waitcnt lgkmcnt(10)
    s_barrier
    v_mfma_f32_16x16x32_bf16 v[100:103], v[196:199], v[24:27], v[100:103]
    ds_read_b64_tr_b16 v[192:193], v228 offset:49152
    v_mfma_f32_16x16x32_bf16 v[108:111], v[196:199], v[28:31], v[108:111]
    ds_read_b64_tr_b16 v[194:195], v228 offset:53248
    v_mfma_f32_16x16x32_bf16 v[116:119], v[196:199], v[32:35], v[116:119]
    v_mfma_f32_16x16x32_bf16 v[120:123], v[200:203], v[24:27], v[120:123]
    ds_read_b64_tr_b16 v[196:197], v229 offset:49152
    v_mfma_f32_16x16x32_bf16 v[128:131], v[200:203], v[28:31], v[128:131]
    ds_read_b64_tr_b16 v[198:199], v229 offset:53248
    v_mfma_f32_16x16x32_bf16 v[136:139], v[200:203], v[32:35], v[136:139]
    s_lshr_b32 s7, 64, s89
    s_bitcmp1_b32 s7, 0
    s_cbranch_scc0 L_KVS82
    s_add_u32 m0, s79, 0
    s_mov_b32 s76, 0
    buffer_load_dwordx4 v255, s[40:43], s76 offen nt lds
    s_add_u32 m0, s79, 4096
    s_mov_b32 s76, 4096
    buffer_load_dwordx4 v255, s[40:43], s76 offen nt lds
    s_add_u32 m0, s79, 8192
    s_mov_b32 s76, 8192
    buffer_load_dwordx4 v255, s[40:43], s76 offen nt lds
    s_add_u32 m0, s79, 12288
    s_mov_b32 s76, 12288
    buffer_load_dwordx4 v255, s[40:43], s76 offen nt lds
    s_add_u32 m0, s79, 16384
    s_mov_b32 s76, 131072
    buffer_load_dwordx4 v255, s[40:43], s76 offen nt lds
    s_add_u32 m0, s79, 20480
    s_mov_b32 s76, 135168
    buffer_load_dwordx4 v255, s[40:43], s76 offen nt lds
    s_add_u32 m0, s79, 24576
    s_mov_b32 s76, 139264
    buffer_load_dwordx4 v255, s[40:43], s76 offen nt lds
    s_add_u32 m0, s79, 28672
    s_mov_b32 s76, 143360
    buffer_load_dwordx4 v255, s[40:43], s76 offen nt lds
    s_add_u32 m0, s79, 32768
    s_mov_b32 s76, 0
    buffer_load_dwordx4 v255, s[44:47], s76 offen nt lds
    s_add_u32 m0, s79, 36864
    s_mov_b32 s76, 4096
    buffer_load_dwordx4 v255, s[44:47], s76 offen nt lds
    s_add_u32 m0, s79, 40960
    s_mov_b32 s76, 8192
    buffer_load_dwordx4 v255, s[44:47], s76 offen nt lds
    s_add_u32 m0, s79, 45056
    s_mov_b32 s76, 12288
    buffer_load_dwordx4 v255, s[44:47], s76 offen nt lds
    s_add_u32 m0, s79, 49152
    s_mov_b32 s76, 131072
    buffer_load_dwordx4 v255, s[44:47], s76 offen nt lds
    s_add_u32 m0, s79, 53248
    s_mov_b32 s76, 135168
    buffer_load_dwordx4 v255, s[44:47], s76 offen nt lds
    s_add_u32 m0, s79, 57344
    s_mov_b32 s76, 139264
    buffer_load_dwordx4 v255, s[44:47], s76 offen nt lds
    s_add_u32 m0, s79, 61440
    s_mov_b32 s76, 143360
    buffer_load_dwordx4 v255, s[44:47], s76 offen nt lds
L_KVS82:
    s_waitcnt lgkmcnt(12)
    v_mfma_f32_16x16x32_bf16 v[124:127], v[204:207], v[24:27], v[124:127]
    ds_read_b64_tr_b16 v[200:201], v230 offset:49152
    v_mfma_f32_16x16x32_bf16 v[132:135], v[204:207], v[28:31], v[132:135]
    ds_read_b64_tr_b16 v[202:203], v230 offset:53248
    v_mfma_f32_16x16x32_bf16 v[140:143], v[204:207], v[32:35], v[140:143]
    s_waitcnt lgkmcnt(12)
    v_mfma_f32_16x16x32_bf16 v[144:147], v[208:211], v[24:27], v[144:147]
    ds_read_b64_tr_b16 v[204:205], v231 offset:49152
    v_mfma_f32_16x16x32_bf16 v[152:155], v[208:211], v[28:31], v[152:155]
    ds_read_b64_tr_b16 v[206:207], v231 offset:53248
    v_mfma_f32_16x16x32_bf16 v[160:163], v[208:211], v[32:35], v[160:163]
    s_waitcnt lgkmcnt(12)
    v_mfma_f32_16x16x32_bf16 v[148:151], v[212:215], v[24:27], v[148:151]
    ds_read_b64_tr_b16 v[208:209], v232 offset:49152
    v_mfma_f32_16x16x32_bf16 v[156:159], v[212:215], v[28:31], v[156:159]
    ds_read_b64_tr_b16 v[210:211], v232 offset:53248
    v_mfma_f32_16x16x32_bf16 v[164:167], v[212:215], v[32:35], v[164:167]
    s_waitcnt lgkmcnt(12)
    v_mfma_f32_16x16x32_bf16 v[168:171], v[216:219], v[24:27], v[168:171]
    ds_read_b64_tr_b16 v[212:213], v233 offset:49152
    v_mfma_f32_16x16x32_bf16 v[176:179], v[216:219], v[28:31], v[176:179]
    ds_read_b64_tr_b16 v[214:215], v233 offset:53248
    v_mfma_f32_16x16x32_bf16 v[184:187], v[216:219], v[32:35], v[184:187]
    s_waitcnt lgkmcnt(12)
    v_mfma_f32_16x16x32_bf16 v[172:175], v[220:223], v[24:27], v[172:175]
    ds_read_b64_tr_b16 v[216:217], v234 offset:49152
    v_mfma_f32_16x16x32_bf16 v[180:183], v[220:223], v[28:31], v[180:183]
    ds_read_b64_tr_b16 v[218:219], v234 offset:53248
    v_mfma_f32_16x16x32_bf16 v[188:191], v[220:223], v[32:35], v[188:191]
    s_waitcnt lgkmcnt(12)
    v_mfma_f32_16x16x32_bf16 v[96:99], v[192:195], v[36:39], v[96:99]
    ds_read_b64_tr_b16 v[220:221], v235 offset:49152
    v_mfma_f32_16x16x32_bf16 v[104:107], v[192:195], v[40:43], v[104:107]
    ds_read_b64_tr_b16 v[222:223], v235 offset:53248
    v_mfma_f32_16x16x32_bf16 v[112:115], v[192:195], v[44:47], v[112:115]
    s_waitcnt lgkmcnt(12)
    s_barrier
    v_mfma_f32_16x16x32_bf16 v[100:103], v[196:199], v[36:39], v[100:103]
    ds_read_b64_tr_b16 v[192:193], v228 offset:0
    v_mfma_f32_16x16x32_bf16 v[108:111], v[196:199], v[40:43], v[108:111]
    ds_read_b64_tr_b16 v[194:195], v228 offset:4096
    v_mfma_f32_16x16x32_bf16 v[116:119], v[196:199], v[44:47], v[116:119]
    ds_read_b128 v[0:3], v251 offset:0
    ds_read_b128 v[4:7], v251 offset:2048
    s_waitcnt lgkmcnt(14)
    v_mfma_f32_16x16x32_bf16 v[120:123], v[200:203], v[36:39], v[120:123]
    ds_read_b64_tr_b16 v[196:197], v229 offset:0
    v_mfma_f32_16x16x32_bf16 v[128:131], v[200:203], v[40:43], v[128:131]
    ds_read_b64_tr_b16 v[198:199], v229 offset:4096
    v_mfma_f32_16x16x32_bf16 v[136:139], v[200:203], v[44:47], v[136:139]
    ds_read_b128 v[8:11], v251 offset:4096
    ds_read_b128 v[12:15], v252 offset:0
    s_lshr_b32 s7, 128, s89
    s_bitcmp1_b32 s7, 0
    s_cbranch_scc0 L_KVS90
    s_add_u32 m0, s79, 0
    s_mov_b32 s76, 0
    buffer_load_dwordx4 v255, s[40:43], s76 offen nt lds
    s_add_u32 m0, s79, 4096
    s_mov_b32 s76, 4096
    buffer_load_dwordx4 v255, s[40:43], s76 offen nt lds
    s_add_u32 m0, s79, 8192
    s_mov_b32 s76, 8192
    buffer_load_dwordx4 v255, s[40:43], s76 offen nt lds
    s_add_u32 m0, s79, 12288
    s_mov_b32 s76, 12288
    buffer_load_dwordx4 v255, s[40:43], s76 offen nt lds
    s_add_u32 m0, s79, 16384
    s_mov_b32 s76, 131072
    buffer_load_dwordx4 v255, s[40:43], s76 offen nt lds
    s_add_u32 m0, s79, 20480
    s_mov_b32 s76, 135168
    buffer_load_dwordx4 v255, s[40:43], s76 offen nt lds
    s_add_u32 m0, s79, 24576
    s_mov_b32 s76, 139264
    buffer_load_dwordx4 v255, s[40:43], s76 offen nt lds
    s_add_u32 m0, s79, 28672
    s_mov_b32 s76, 143360
    buffer_load_dwordx4 v255, s[40:43], s76 offen nt lds
    s_add_u32 m0, s79, 32768
    s_mov_b32 s76, 0
    buffer_load_dwordx4 v255, s[44:47], s76 offen nt lds
    s_add_u32 m0, s79, 36864
    s_mov_b32 s76, 4096
    buffer_load_dwordx4 v255, s[44:47], s76 offen nt lds
    s_add_u32 m0, s79, 40960
    s_mov_b32 s76, 8192
    buffer_load_dwordx4 v255, s[44:47], s76 offen nt lds
    s_add_u32 m0, s79, 45056
    s_mov_b32 s76, 12288
    buffer_load_dwordx4 v255, s[44:47], s76 offen nt lds
    s_add_u32 m0, s79, 49152
    s_mov_b32 s76, 131072
    buffer_load_dwordx4 v255, s[44:47], s76 offen nt lds
    s_add_u32 m0, s79, 53248
    s_mov_b32 s76, 135168
    buffer_load_dwordx4 v255, s[44:47], s76 offen nt lds
    s_add_u32 m0, s79, 57344
    s_mov_b32 s76, 139264
    buffer_load_dwordx4 v255, s[44:47], s76 offen nt lds
    s_add_u32 m0, s79, 61440
    s_mov_b32 s76, 143360
    buffer_load_dwordx4 v255, s[44:47], s76 offen nt lds
L_KVS90:
    s_waitcnt lgkmcnt(15)
    v_mfma_f32_16x16x32_bf16 v[124:127], v[204:207], v[36:39], v[124:127]
    ds_read_b64_tr_b16 v[200:201], v230 offset:0
    v_mfma_f32_16x16x32_bf16 v[132:135], v[204:207], v[40:43], v[132:135]
    ds_read_b64_tr_b16 v[202:203], v230 offset:4096
    v_mfma_f32_16x16x32_bf16 v[140:143], v[204:207], v[44:47], v[140:143]
    ds_read_b128 v[16:19], v252 offset:2048
    ds_read_b128 v[20:23], v252 offset:4096
    s_waitcnt lgkmcnt(15)
    v_mfma_f32_16x16x32_bf16 v[144:147], v[208:211], v[36:39], v[144:147]
    ds_read_b64_tr_b16 v[204:205], v231 offset:0
    v_mfma_f32_16x16x32_bf16 v[152:155], v[208:211], v[40:43], v[152:155]
    ds_read_b64_tr_b16 v[206:207], v231 offset:4096
    v_mfma_f32_16x16x32_bf16 v[160:163], v[208:211], v[44:47], v[160:163]
    v_mfma_f32_16x16x32_bf16 v[148:151], v[212:215], v[36:39], v[148:151]
    ds_read_b64_tr_b16 v[208:209], v232 offset:0
    v_mfma_f32_16x16x32_bf16 v[156:159], v[212:215], v[40:43], v[156:159]
    ds_read_b64_tr_b16 v[210:211], v232 offset:4096
    v_mfma_f32_16x16x32_bf16 v[164:167], v[212:215], v[44:47], v[164:167]
    s_waitcnt lgkmcnt(15)
    v_mfma_f32_16x16x32_bf16 v[168:171], v[216:219], v[36:39], v[168:171]
    ds_read_b64_tr_b16 v[212:213], v233 offset:0
    v_mfma_f32_16x16x32_bf16 v[176:179], v[216:219], v[40:43], v[176:179]
    ds_read_b64_tr_b16 v[214:215], v233 offset:4096
    v_mfma_f32_16x16x32_bf16 v[184:187], v[216:219], v[44:47], v[184:187]
    v_mfma_f32_16x16x32_bf16 v[172:175], v[220:223], v[36:39], v[172:175]
    ds_read_b64_tr_b16 v[216:217], v234 offset:0
    v_mfma_f32_16x16x32_bf16 v[180:183], v[220:223], v[40:43], v[180:183]
    ds_read_b64_tr_b16 v[218:219], v234 offset:4096
    v_mfma_f32_16x16x32_bf16 v[188:191], v[220:223], v[44:47], v[188:191]
    s_waitcnt lgkmcnt(13)
    v_mfma_f32_16x16x32_bf16 v[96:99], v[192:195], v[0:3], v[96:99]
    ds_read_b64_tr_b16 v[220:221], v235 offset:0
    v_mfma_f32_16x16x32_bf16 v[104:107], v[192:195], v[4:7], v[104:107]
    ds_read_b64_tr_b16 v[222:223], v235 offset:4096
    v_mfma_f32_16x16x32_bf16 v[112:115], v[192:195], v[8:11], v[112:115]
    s_waitcnt lgkmcnt(10)
    s_barrier
    v_mfma_f32_16x16x32_bf16 v[100:103], v[196:199], v[0:3], v[100:103]
    ds_read_b64_tr_b16 v[192:193], v228 offset:16384
    v_mfma_f32_16x16x32_bf16 v[108:111], v[196:199], v[4:7], v[108:111]
    ds_read_b64_tr_b16 v[194:195], v228 offset:20480
    v_mfma_f32_16x16x32_bf16 v[116:119], v[196:199], v[8:11], v[116:119]
    v_mfma_f32_16x16x32_bf16 v[120:123], v[200:203], v[0:3], v[120:123]
    ds_read_b64_tr_b16 v[196:197], v229 offset:16384
    v_mfma_f32_16x16x32_bf16 v[128:131], v[200:203], v[4:7], v[128:131]
    ds_read_b64_tr_b16 v[198:199], v229 offset:20480
    v_mfma_f32_16x16x32_bf16 v[136:139], v[200:203], v[8:11], v[136:139]
    s_waitcnt lgkmcnt(12)
    v_mfma_f32_16x16x32_bf16 v[124:127], v[204:207], v[0:3], v[124:127]
    ds_read_b64_tr_b16 v[200:201], v230 offset:16384
    v_mfma_f32_16x16x32_bf16 v[132:135], v[204:207], v[4:7], v[132:135]
    ds_read_b64_tr_b16 v[202:203], v230 offset:20480
    v_mfma_f32_16x16x32_bf16 v[140:143], v[204:207], v[8:11], v[140:143]
    s_waitcnt lgkmcnt(12)
    v_mfma_f32_16x16x32_bf16 v[144:147], v[208:211], v[0:3], v[144:147]
    ds_read_b64_tr_b16 v[204:205], v231 offset:16384
    v_mfma_f32_16x16x32_bf16 v[152:155], v[208:211], v[4:7], v[152:155]
    ds_read_b64_tr_b16 v[206:207], v231 offset:20480
    v_mfma_f32_16x16x32_bf16 v[160:163], v[208:211], v[8:11], v[160:163]
    s_waitcnt lgkmcnt(12)
    v_mfma_f32_16x16x32_bf16 v[148:151], v[212:215], v[0:3], v[148:151]
    ds_read_b64_tr_b16 v[208:209], v232 offset:16384
    v_mfma_f32_16x16x32_bf16 v[156:159], v[212:215], v[4:7], v[156:159]
    ds_read_b64_tr_b16 v[210:211], v232 offset:20480
    v_mfma_f32_16x16x32_bf16 v[164:167], v[212:215], v[8:11], v[164:167]
    s_waitcnt lgkmcnt(12)
    v_mfma_f32_16x16x32_bf16 v[168:171], v[216:219], v[0:3], v[168:171]
    ds_read_b64_tr_b16 v[212:213], v233 offset:16384
    v_mfma_f32_16x16x32_bf16 v[176:179], v[216:219], v[4:7], v[176:179]
    ds_read_b64_tr_b16 v[214:215], v233 offset:20480
    v_mfma_f32_16x16x32_bf16 v[184:187], v[216:219], v[8:11], v[184:187]
    s_waitcnt lgkmcnt(12)
    v_mfma_f32_16x16x32_bf16 v[172:175], v[220:223], v[0:3], v[172:175]
    ds_read_b64_tr_b16 v[216:217], v234 offset:16384
    v_mfma_f32_16x16x32_bf16 v[180:183], v[220:223], v[4:7], v[180:183]
    ds_read_b64_tr_b16 v[218:219], v234 offset:20480
    v_mfma_f32_16x16x32_bf16 v[188:191], v[220:223], v[8:11], v[188:191]
    s_waitcnt lgkmcnt(12)
    v_mfma_f32_16x16x32_bf16 v[96:99], v[192:195], v[12:15], v[96:99]
    ds_read_b64_tr_b16 v[220:221], v235 offset:16384
    v_mfma_f32_16x16x32_bf16 v[104:107], v[192:195], v[16:19], v[104:107]
    ds_read_b64_tr_b16 v[222:223], v235 offset:20480
    v_mfma_f32_16x16x32_bf16 v[112:115], v[192:195], v[20:23], v[112:115]
    s_waitcnt lgkmcnt(12)
    s_barrier
    v_mfma_f32_16x16x32_bf16 v[100:103], v[196:199], v[12:15], v[100:103]
    ds_read_b64_tr_b16 v[192:193], v228 offset:32768
    v_mfma_f32_16x16x32_bf16 v[108:111], v[196:199], v[16:19], v[108:111]
    ds_read_b64_tr_b16 v[194:195], v228 offset:36864
    v_mfma_f32_16x16x32_bf16 v[116:119], v[196:199], v[20:23], v[116:119]
    ds_read_b128 v[24:27], v251 offset:12288
    ds_read_b128 v[28:31], v251 offset:14336
    s_waitcnt lgkmcnt(14)
    v_mfma_f32_16x16x32_bf16 v[120:123], v[200:203], v[12:15], v[120:123]
    ds_read_b64_tr_b16 v[196:197], v229 offset:32768
    v_mfma_f32_16x16x32_bf16 v[128:131], v[200:203], v[16:19], v[128:131]
    ds_read_b64_tr_b16 v[198:199], v229 offset:36864
    v_mfma_f32_16x16x32_bf16 v[136:139], v[200:203], v[20:23], v[136:139]
    ds_read_b128 v[32:35], v251 offset:16384
    ds_read_b128 v[36:39], v252 offset:12288
    s_waitcnt lgkmcnt(15)
    v_mfma_f32_16x16x32_bf16 v[124:127], v[204:207], v[12:15], v[124:127]
    ds_read_b64_tr_b16 v[200:201], v230 offset:32768
    v_mfma_f32_16x16x32_bf16 v[132:135], v[204:207], v[16:19], v[132:135]
    ds_read_b64_tr_b16 v[202:203], v230 offset:36864
    v_mfma_f32_16x16x32_bf16 v[140:143], v[204:207], v[20:23], v[140:143]
    ds_read_b128 v[40:43], v252 offset:14336
    ds_read_b128 v[44:47], v252 offset:16384
    s_waitcnt lgkmcnt(15)
    v_mfma_f32_16x16x32_bf16 v[144:147], v[208:211], v[12:15], v[144:147]
    ds_read_b64_tr_b16 v[204:205], v231 offset:32768
    v_mfma_f32_16x16x32_bf16 v[152:155], v[208:211], v[16:19], v[152:155]
    ds_read_b64_tr_b16 v[206:207], v231 offset:36864
    v_mfma_f32_16x16x32_bf16 v[160:163], v[208:211], v[20:23], v[160:163]
    v_mfma_f32_16x16x32_bf16 v[148:151], v[212:215], v[12:15], v[148:151]
    ds_read_b64_tr_b16 v[208:209], v232 offset:32768
    v_mfma_f32_16x16x32_bf16 v[156:159], v[212:215], v[16:19], v[156:159]
    ds_read_b64_tr_b16 v[210:211], v232 offset:36864
    v_mfma_f32_16x16x32_bf16 v[164:167], v[212:215], v[20:23], v[164:167]
    s_waitcnt lgkmcnt(15)
    v_mfma_f32_16x16x32_bf16 v[168:171], v[216:219], v[12:15], v[168:171]
    ds_read_b64_tr_b16 v[212:213], v233 offset:32768
    v_mfma_f32_16x16x32_bf16 v[176:179], v[216:219], v[16:19], v[176:179]
    ds_read_b64_tr_b16 v[214:215], v233 offset:36864
    v_mfma_f32_16x16x32_bf16 v[184:187], v[216:219], v[20:23], v[184:187]
    v_mfma_f32_16x16x32_bf16 v[172:175], v[220:223], v[12:15], v[172:175]
    ds_read_b64_tr_b16 v[216:217], v234 offset:32768
    v_mfma_f32_16x16x32_bf16 v[180:183], v[220:223], v[16:19], v[180:183]
    ds_read_b64_tr_b16 v[218:219], v234 offset:36864
    v_mfma_f32_16x16x32_bf16 v[188:191], v[220:223], v[20:23], v[188:191]
    s_waitcnt lgkmcnt(13)
    v_mfma_f32_16x16x32_bf16 v[96:99], v[192:195], v[24:27], v[96:99]
    ds_read_b64_tr_b16 v[220:221], v235 offset:32768
    v_mfma_f32_16x16x32_bf16 v[104:107], v[192:195], v[28:31], v[104:107]
    ds_read_b64_tr_b16 v[222:223], v235 offset:36864
    v_mfma_f32_16x16x32_bf16 v[112:115], v[192:195], v[32:35], v[112:115]
    s_waitcnt lgkmcnt(10)
    s_barrier
    v_mfma_f32_16x16x32_bf16 v[100:103], v[196:199], v[24:27], v[100:103]
    ds_read_b64_tr_b16 v[192:193], v228 offset:49152
    v_mfma_f32_16x16x32_bf16 v[108:111], v[196:199], v[28:31], v[108:111]
    ds_read_b64_tr_b16 v[194:195], v228 offset:53248
    v_mfma_f32_16x16x32_bf16 v[116:119], v[196:199], v[32:35], v[116:119]
    v_mov_b32 v0, 0
    v_mov_b32 v1, 0
    v_mfma_f32_16x16x32_bf16 v[120:123], v[200:203], v[24:27], v[120:123]
    ds_read_b64_tr_b16 v[196:197], v229 offset:49152
    v_mfma_f32_16x16x32_bf16 v[128:131], v[200:203], v[28:31], v[128:131]
    ds_read_b64_tr_b16 v[198:199], v229 offset:53248
    v_mfma_f32_16x16x32_bf16 v[136:139], v[200:203], v[32:35], v[136:139]
    v_mov_b32 v2, 0
    v_mov_b32 v3, 0
    s_waitcnt lgkmcnt(12)
    v_mfma_f32_16x16x32_bf16 v[124:127], v[204:207], v[24:27], v[124:127]
    ds_read_b64_tr_b16 v[200:201], v230 offset:49152
    v_mfma_f32_16x16x32_bf16 v[132:135], v[204:207], v[28:31], v[132:135]
    ds_read_b64_tr_b16 v[202:203], v230 offset:53248
    v_mfma_f32_16x16x32_bf16 v[140:143], v[204:207], v[32:35], v[140:143]
    v_mov_b32 v4, 0
    v_mov_b32 v5, 0
    s_waitcnt lgkmcnt(12)
    v_mfma_f32_16x16x32_bf16 v[144:147], v[208:211], v[24:27], v[144:147]
    ds_read_b64_tr_b16 v[204:205], v231 offset:49152
    v_mfma_f32_16x16x32_bf16 v[152:155], v[208:211], v[28:31], v[152:155]
    ds_read_b64_tr_b16 v[206:207], v231 offset:53248
    v_mfma_f32_16x16x32_bf16 v[160:163], v[208:211], v[32:35], v[160:163]
    v_mov_b32 v6, 0
    v_mov_b32 v7, 0
    s_waitcnt lgkmcnt(12)
    v_mfma_f32_16x16x32_bf16 v[148:151], v[212:215], v[24:27], v[148:151]
    ds_read_b64_tr_b16 v[208:209], v232 offset:49152
    v_mfma_f32_16x16x32_bf16 v[156:159], v[212:215], v[28:31], v[156:159]
    ds_read_b64_tr_b16 v[210:211], v232 offset:53248
    v_mfma_f32_16x16x32_bf16 v[164:167], v[212:215], v[32:35], v[164:167]
    v_mov_b32 v8, 0
    v_mov_b32 v9, 0
    s_waitcnt lgkmcnt(12)
    v_mfma_f32_16x16x32_bf16 v[168:171], v[216:219], v[24:27], v[168:171]
    ds_read_b64_tr_b16 v[212:213], v233 offset:49152
    v_mfma_f32_16x16x32_bf16 v[176:179], v[216:219], v[28:31], v[176:179]
    ds_read_b64_tr_b16 v[214:215], v233 offset:53248
    v_mfma_f32_16x16x32_bf16 v[184:187], v[216:219], v[32:35], v[184:187]
    v_mov_b32 v10, 0
    v_mov_b32 v11, 0
    s_waitcnt lgkmcnt(12)
    v_mfma_f32_16x16x32_bf16 v[172:175], v[220:223], v[24:27], v[172:175]
    ds_read_b64_tr_b16 v[216:217], v234 offset:49152
    v_mfma_f32_16x16x32_bf16 v[180:183], v[220:223], v[28:31], v[180:183]
    ds_read_b64_tr_b16 v[218:219], v234 offset:53248
    v_mfma_f32_16x16x32_bf16 v[188:191], v[220:223], v[32:35], v[188:191]
    v_mov_b32 v12, 0
    v_mov_b32 v13, 0
    s_waitcnt lgkmcnt(12)
    v_mfma_f32_16x16x32_bf16 v[96:99], v[192:195], v[36:39], v[96:99]
    ds_read_b64_tr_b16 v[220:221], v235 offset:49152
    v_mfma_f32_16x16x32_bf16 v[104:107], v[192:195], v[40:43], v[104:107]
    ds_read_b64_tr_b16 v[222:223], v235 offset:53248
    v_mfma_f32_16x16x32_bf16 v[112:115], v[192:195], v[44:47], v[112:115]
    v_mov_b32 v14, 0
    v_mov_b32 v15, 0
    s_waitcnt lgkmcnt(12)
    v_mfma_f32_16x16x32_bf16 v[100:103], v[196:199], v[36:39], v[100:103]
    v_mfma_f32_16x16x32_bf16 v[108:111], v[196:199], v[40:43], v[108:111]
    v_mfma_f32_16x16x32_bf16 v[116:119], v[196:199], v[44:47], v[116:119]
    v_mov_b32 v16, 0
    v_mov_b32 v17, 0
    v_mov_b32 v24, 0
    v_mov_b32 v25, 0
    s_waitcnt lgkmcnt(10)
    v_mfma_f32_16x16x32_bf16 v[120:123], v[200:203], v[36:39], v[120:123]
    v_mfma_f32_16x16x32_bf16 v[128:131], v[200:203], v[40:43], v[128:131]
    v_mfma_f32_16x16x32_bf16 v[136:139], v[200:203], v[44:47], v[136:139]
    v_mov_b32 v18, 0
    v_mov_b32 v19, 0
    v_mov_b32 v26, 0
    v_mov_b32 v27, 0
    s_waitcnt lgkmcnt(8)
    v_mfma_f32_16x16x32_bf16 v[124:127], v[204:207], v[36:39], v[124:127]
    v_mfma_f32_16x16x32_bf16 v[132:135], v[204:207], v[40:43], v[132:135]
    v_mfma_f32_16x16x32_bf16 v[140:143], v[204:207], v[44:47], v[140:143]
    v_mov_b32 v20, 0
    v_mov_b32 v21, 0
    v_mov_b32 v28, 0
    v_mov_b32 v29, 0
    v_cvt_pk_bf16_f32 v96, v96, v97
    v_cvt_pk_bf16_f32 v97, v98, v99
    v_cvt_pk_bf16_f32 v98, v100, v101
    v_cvt_pk_bf16_f32 v99, v102, v103
    v_cvt_pk_bf16_f32 v104, v104, v105
    v_cvt_pk_bf16_f32 v105, v106, v107
    s_waitcnt lgkmcnt(6)
    v_mfma_f32_16x16x32_bf16 v[144:147], v[208:211], v[36:39], v[144:147]
    v_mfma_f32_16x16x32_bf16 v[152:155], v[208:211], v[40:43], v[152:155]
    v_mfma_f32_16x16x32_bf16 v[160:163], v[208:211], v[44:47], v[160:163]
    v_mov_b32 v22, 0
    v_mov_b32 v23, 0
    v_mov_b32 v30, 0
    v_mov_b32 v31, 0
    v_cvt_pk_bf16_f32 v106, v108, v109
    v_cvt_pk_bf16_f32 v107, v110, v111
    v_cvt_pk_bf16_f32 v112, v112, v113
    v_cvt_pk_bf16_f32 v113, v114, v115
    v_cvt_pk_bf16_f32 v114, v116, v117
    v_cvt_pk_bf16_f32 v115, v118, v119
    s_waitcnt lgkmcnt(4)
    v_mfma_f32_16x16x32_bf16 v[148:151], v[212:215], v[36:39], v[148:151]
    v_mfma_f32_16x16x32_bf16 v[156:159], v[212:215], v[40:43], v[156:159]
    v_mfma_f32_16x16x32_bf16 v[164:167], v[212:215], v[44:47], v[164:167]
    v_mov_b32 v32, 0
    v_mov_b32 v33, 0
    v_cvt_pk_bf16_f32 v120, v120, v121
    v_cvt_pk_bf16_f32 v121, v122, v123
    v_cvt_pk_bf16_f32 v122, v124, v125
    v_cvt_pk_bf16_f32 v123, v126, v127
    v_cvt_pk_bf16_f32 v128, v128, v129
    v_cvt_pk_bf16_f32 v129, v130, v131
    s_waitcnt lgkmcnt(2)
    v_mfma_f32_16x16x32_bf16 v[168:171], v[216:219], v[36:39], v[168:171]
    v_mfma_f32_16x16x32_bf16 v[176:179], v[216:219], v[40:43], v[176:179]
    v_mfma_f32_16x16x32_bf16 v[184:187], v[216:219], v[44:47], v[184:187]
    v_mov_b32 v34, 0
    v_mov_b32 v35, 0
    v_cvt_pk_bf16_f32 v130, v132, v133
    v_cvt_pk_bf16_f32 v131, v134, v135
    v_cvt_pk_bf16_f32 v136, v136, v137
    v_cvt_pk_bf16_f32 v137, v138, v139
    v_cvt_pk_bf16_f32 v138, v140, v141
    v_cvt_pk_bf16_f32 v139, v142, v143
    s_waitcnt lgkmcnt(0)
    v_mfma_f32_16x16x32_bf16 v[172:175], v[220:223], v[36:39], v[172:175]
    v_mfma_f32_16x16x32_bf16 v[180:183], v[220:223], v[40:43], v[180:183]
    v_mfma_f32_16x16x32_bf16 v[188:191], v[220:223], v[44:47], v[188:191]
    v_cvt_pk_bf16_f32 v144, v144, v145
    v_cvt_pk_bf16_f32 v145, v146, v147
    v_cvt_pk_bf16_f32 v146, v148, v149
    v_cvt_pk_bf16_f32 v147, v150, v151
    v_cvt_pk_bf16_f32 v152, v152, v153
    v_cvt_pk_bf16_f32 v153, v154, v155
    v_cvt_pk_bf16_f32 v154, v156, v157
    v_cvt_pk_bf16_f32 v155, v158, v159
    v_cvt_pk_bf16_f32 v160, v160, v161
    v_cvt_pk_bf16_f32 v161, v162, v163
    v_cvt_pk_bf16_f32 v162, v164, v165
    v_cvt_pk_bf16_f32 v163, v166, v167
    v_mov_b32 v36, 0
    v_mov_b32 v37, 0
    v_mov_b32 v38, 0
    v_mov_b32 v39, 0
    v_mov_b32 v40, 0
    v_mov_b32 v41, 0
    v_mov_b32 v42, 0
    v_mov_b32 v43, 0
    v_mov_b32 v44, 0
    v_mov_b32 v45, 0
    v_mov_b32 v46, 0
    v_mov_b32 v47, 0
    v_mov_b32 v236, 0xff800000
    v_mov_b32 v239, 0
    v_mov_b32 v237, 0xff800000
    v_mov_b32 v240, 0
    v_mov_b32 v238, 0xff800000
    v_mov_b32 v241, 0
    v_cvt_pk_bf16_f32 v168, v168, v169
    v_cvt_pk_bf16_f32 v169, v170, v171
    v_cvt_pk_bf16_f32 v170, v172, v173
    v_cvt_pk_bf16_f32 v171, v174, v175
    v_cvt_pk_bf16_f32 v176, v176, v177
    v_cvt_pk_bf16_f32 v177, v178, v179
    v_cvt_pk_bf16_f32 v178, v180, v181
    v_cvt_pk_bf16_f32 v179, v182, v183
    v_cvt_pk_bf16_f32 v184, v184, v185
    v_cvt_pk_bf16_f32 v185, v186, v187
    v_cvt_pk_bf16_f32 v186, v188, v189
    v_cvt_pk_bf16_f32 v187, v190, v191
    v_mov_b32 v248, 0x7f800000
    v_mov_b32 v249, 0x7f800000
    v_mov_b32 v250, 0x7f800000
    s_waitcnt vmcnt(8)
    s_mov_b32 s64, 8
L_ATT:
    v_mov_b32 v228, v224
    v_xor_b32 v229, 32, v228
    v_xor_b32 v230, 64, v228
    v_xor_b32 v231, 96, v228
    v_xor_b32 v232, 128, v228
    v_xor_b32 v233, 160, v228
    v_xor_b32 v234, 192, v228
    v_xor_b32 v235, 224, v228
    s_barrier
    ds_read_b64 v[192:193], v228 offset:0
    ds_read_b64 v[194:195], v229 offset:0
    ds_read_b64 v[196:197], v230 offset:0
    ds_read_b64 v[198:199], v231 offset:0
    ds_read_b64 v[200:201], v232 offset:0
    ds_read_b64 v[202:203], v233 offset:0
    ds_read_b64 v[204:205], v234 offset:0
    ds_read_b64 v[206:207], v235 offset:0
    ds_read_b64 v[208:209], v228 offset:4096
    ds_read_b64 v[210:211], v229 offset:4096
    ds_read_b64 v[212:213], v230 offset:4096
    ds_read_b64 v[214:215], v231 offset:4096
    ds_read_b64 v[216:217], v232 offset:4096
    ds_read_b64 v[218:219], v233 offset:4096
    s_waitcnt lgkmcnt(12)
    v_mfma_f32_16x16x32_bf16 v[100:103], v[192:195], v[96:99], 0
    ds_read_b64 v[220:221], v234 offset:4096
    v_mfma_f32_16x16x32_bf16 v[108:111], v[192:195], v[104:107], 0
    ds_read_b64 v[222:223], v235 offset:4096
    v_mfma_f32_16x16x32_bf16 v[116:119], v[192:195], v[112:115], 0
    s_waitcnt lgkmcnt(12)
    v_mfma_f32_16x16x32_bf16 v[100:103], v[196:199], v[120:123], v[100:103]
    ds_read_b64 v[192:193], v228 offset:8192
    v_mfma_f32_16x16x32_bf16 v[108:111], v[196:199], v[128:131], v[108:111]
    ds_read_b64 v[194:195], v229 offset:8192
    v_mfma_f32_16x16x32_bf16 v[116:119], v[196:199], v[136:139], v[116:119]
    s_waitcnt lgkmcnt(12)
    v_mfma_f32_16x16x32_bf16 v[100:103], v[200:203], v[144:147], v[100:103]
    ds_read_b64 v[196:197], v230 offset:8192
    v_mfma_f32_16x16x32_bf16 v[108:111], v[200:203], v[152:155], v[108:111]
    ds_read_b64 v[198:199], v231 offset:8192
    v_mfma_f32_16x16x32_bf16 v[116:119], v[200:203], v[160:163], v[116:119]
    s_waitcnt lgkmcnt(12)
    v_mfma_f32_16x16x32_bf16 v[100:103], v[204:207], v[168:171], v[100:103]
    ds_read_b64 v[200:201], v232 offset:8192
    v_mfma_f32_16x16x32_bf16 v[108:111], v[204:207], v[176:179], v[108:111]
    ds_read_b64 v[202:203], v233 offset:8192
    v_mfma_f32_16x16x32_bf16 v[116:119], v[204:207], v[184:187], v[116:119]
    s_waitcnt lgkmcnt(12)
    v_mfma_f32_16x16x32_bf16 v[124:127], v[208:211], v[96:99], 0
    ds_read_b64 v[204:205], v234 offset:8192
    v_mfma_f32_16x16x32_bf16 v[132:135], v[208:211], v[104:107], 0
    ds_read_b64 v[206:207], v235 offset:8192
    v_mfma_f32_16x16x32_bf16 v[140:143], v[208:211], v[112:115], 0
    s_waitcnt lgkmcnt(12)
    v_mfma_f32_16x16x32_bf16 v[124:127], v[212:215], v[120:123], v[124:127]
    ds_read_b64 v[208:209], v228 offset:12288
    v_mfma_f32_16x16x32_bf16 v[132:135], v[212:215], v[128:131], v[132:135]
    ds_read_b64 v[210:211], v229 offset:12288
    v_mfma_f32_16x16x32_bf16 v[140:143], v[212:215], v[136:139], v[140:143]
    s_waitcnt lgkmcnt(12)
    v_mfma_f32_16x16x32_bf16 v[124:127], v[216:219], v[144:147], v[124:127]
    ds_read_b64 v[212:213], v230 offset:12288
    v_max3_f32 v243, v100, v101, v102
    v_mfma_f32_16x16x32_bf16 v[132:135], v[216:219], v[152:155], v[132:135]
    ds_read_b64 v[214:215], v231 offset:12288
    v_max3_f32 v245, v108, v109, v110
    v_mfma_f32_16x16x32_bf16 v[140:143], v[216:219], v[160:163], v[140:143]
    v_max3_f32 v247, v116, v117, v118
    s_waitcnt lgkmcnt(12)
    v_mfma_f32_16x16x32_bf16 v[124:127], v[220:223], v[168:171], v[124:127]
    ds_read_b64 v[216:217], v232 offset:12288
    v_max_f32 v243, v243, v103
    v_mfma_f32_16x16x32_bf16 v[132:135], v[220:223], v[176:179], v[132:135]
    ds_read_b64 v[218:219], v233 offset:12288
    v_max_f32 v245, v245, v111
    v_mfma_f32_16x16x32_bf16 v[140:143], v[220:223], v[184:187], v[140:143]
    v_max_f32 v247, v247, v119
    s_waitcnt lgkmcnt(12)
    v_mfma_f32_16x16x32_bf16 v[148:151], v[192:195], v[96:99], 0
    ds_read_b64 v[220:221], v234 offset:12288
    v_mfma_f32_16x16x32_bf16 v[156:159], v[192:195], v[104:107], 0
    ds_read_b64 v[222:223], v235 offset:12288
    v_mfma_f32_16x16x32_bf16 v[164:167], v[192:195], v[112:115], 0
    s_waitcnt lgkmcnt(12)
    v_mfma_f32_16x16x32_bf16 v[148:151], v[196:199], v[120:123], v[148:151]
    v_mfma_f32_16x16x32_bf16 v[156:159], v[196:199], v[128:131], v[156:159]
    v_mfma_f32_16x16x32_bf16 v[164:167], v[196:199], v[136:139], v[164:167]
    s_waitcnt lgkmcnt(10)
    v_mfma_f32_16x16x32_bf16 v[148:151], v[200:203], v[144:147], v[148:151]
    v_max3_f32 v243, v243, v124, v125
    v_mfma_f32_16x16x32_bf16 v[156:159], v[200:203], v[152:155], v[156:159]
    v_max3_f32 v245, v245, v132, v133
    v_mfma_f32_16x16x32_bf16 v[164:167], v[200:203], v[160:163], v[164:167]
    v_max3_f32 v247, v247, v140, v141
    s_waitcnt lgkmcnt(8)
    v_mfma_f32_16x16x32_bf16 v[148:151], v[204:207], v[168:171], v[148:151]
    v_max3_f32 v243, v243, v126, v127
    v_mfma_f32_16x16x32_bf16 v[156:159], v[204:207], v[176:179], v[156:159]
    v_max3_f32 v245, v245, v134, v135
    v_mfma_f32_16x16x32_bf16 v[164:167], v[204:207], v[184:187], v[164:167]
    v_max3_f32 v247, v247, v142, v143
    s_waitcnt lgkmcnt(6)
    v_mfma_f32_16x16x32_bf16 v[172:175], v[208:211], v[96:99], 0
    v_mfma_f32_16x16x32_bf16 v[180:183], v[208:211], v[104:107], 0
    v_mfma_f32_16x16x32_bf16 v[188:191], v[208:211], v[112:115], 0
    s_waitcnt lgkmcnt(4)
    v_mfma_f32_16x16x32_bf16 v[172:175], v[212:215], v[120:123], v[172:175]
    v_mfma_f32_16x16x32_bf16 v[180:183], v[212:215], v[128:131], v[180:183]
    v_mfma_f32_16x16x32_bf16 v[188:191], v[212:215], v[136:139], v[188:191]
    s_waitcnt lgkmcnt(2)
    v_mfma_f32_16x16x32_bf16 v[172:175], v[216:219], v[144:147], v[172:175]
    v_max3_f32 v243, v243, v148, v149
    v_mfma_f32_16x16x32_bf16 v[180:183], v[216:219], v[152:155], v[180:183]
    v_max3_f32 v245, v245, v156, v157
    v_mfma_f32_16x16x32_bf16 v[188:191], v[216:219], v[160:163], v[188:191]
    v_max3_f32 v247, v247, v164, v165
    s_waitcnt lgkmcnt(0)
    v_mfma_f32_16x16x32_bf16 v[172:175], v[220:223], v[168:171], v[172:175]
    v_max3_f32 v243, v243, v150, v151
    v_mfma_f32_16x16x32_bf16 v[180:183], v[220:223], v[176:179], v[180:183]
    v_max3_f32 v245, v245, v158, v159
    v_mfma_f32_16x16x32_bf16 v[188:191], v[220:223], v[184:187], v[188:191]
    v_max3_f32 v247, v247, v166, v167
    v_mov_b32 v228, v225
    v_xor_b32 v229, 32, v228
    v_xor_b32 v230, 64, v228
    v_xor_b32 v231, 96, v228
    v_xor_b32 v232, 128, v228
    v_xor_b32 v233, 160, v228
    v_xor_b32 v234, 192, v228
    v_xor_b32 v235, 224, v228
    v_xor_b32 v224, 65536, v224
    v_xor_b32 v225, 65536, v225
    v_max3_f32 v243, v243, v172, v173
    v_max3_f32 v245, v245, v180, v181
    v_max3_f32 v247, v247, v188, v189
    v_max3_f32 v243, v243, v174, v175
    v_max3_f32 v245, v245, v182, v183
    v_max3_f32 v247, v247, v190, v191
    v_fma_f32 v251, v243, s62, v248
    v_fma_f32 v252, v245, s62, v249
    v_fma_f32 v253, v247, s62, v250
    v_max3_f32 v251, v251, v252, v253
    v_cmp_lt_f32 vcc, 0x41000000, v251
    s_cbranch_vccz L_FAST
    v_max_f32 v243, v243, v236
    v_max_f32 v245, v245, v237
    v_max_f32 v247, v247, v238
    v_mov_b32 v251, v243
    v_mov_b32 v252, v245
    v_mov_b32 v253, v247
    s_nop 0
    v_permlane16_swap_b32 v243, v251
    v_permlane16_swap_b32 v245, v252
    v_permlane16_swap_b32 v247, v253
    s_nop 0
    v_max_f32 v243, v243, v251
    v_max_f32 v245, v245, v252
    v_max_f32 v247, v247, v253
    v_mov_b32 v251, v243
    v_mov_b32 v252, v245
    v_mov_b32 v253, v247
    s_nop 0
    v_permlane32_swap_b32 v243, v251
    v_permlane32_swap_b32 v245, v252
    v_permlane32_swap_b32 v247, v253
    s_nop 0
    v_max_f32 v243, v243, v251
    v_max_f32 v245, v245, v252
    v_max_f32 v247, v247, v253
    v_sub_f32 v251, v236, v243
    v_sub_f32 v252, v237, v245
    v_sub_f32 v253, v238, v247
    v_mul_f32 v251, s62, v251
    v_mul_f32 v252, s62, v252
    v_mul_f32 v253, s62, v253
    v_exp_f32 v242, v251
    v_exp_f32 v244, v252
    v_exp_f32 v246, v253
    v_mov_b32 v236, v243
    v_mov_b32 v237, v245
    v_mov_b32 v238, v247
    v_mul_f32 v248, s63, v243
    v_mul_f32 v249, s63, v245
    v_mul_f32 v250, s63, v247
    v_mul_f32 v239, v239, v242
    v_mul_f32 v240, v240, v244
    v_mul_f32 v241, v241, v246
    v_pk_mul_f32 v[0:1], v[0:1], v[242:243] op_sel_hi:[1,0]
    v_pk_mul_f32 v[2:3], v[2:3], v[242:243] op_sel_hi:[1,0]
    v_pk_mul_f32 v[4:5], v[4:5], v[244:245] op_sel_hi:[1,0]
    v_pk_mul_f32 v[6:7], v[6:7], v[244:245] op_sel_hi:[1,0]
    v_pk_mul_f32 v[8:9], v[8:9], v[246:247] op_sel_hi:[1,0]
    v_pk_mul_f32 v[10:11], v[10:11], v[246:247] op_sel_hi:[1,0]
    v_pk_mul_f32 v[12:13], v[12:13], v[242:243] op_sel_hi:[1,0]
    v_pk_mul_f32 v[14:15], v[14:15], v[242:243] op_sel_hi:[1,0]
    v_pk_mul_f32 v[16:17], v[16:17], v[244:245] op_sel_hi:[1,0]
    v_pk_mul_f32 v[18:19], v[18:19], v[244:245] op_sel_hi:[1,0]
    v_pk_mul_f32 v[20:21], v[20:21], v[246:247] op_sel_hi:[1,0]
    v_pk_mul_f32 v[22:23], v[22:23], v[246:247] op_sel_hi:[1,0]
    v_pk_mul_f32 v[24:25], v[24:25], v[242:243] op_sel_hi:[1,0]
    v_pk_mul_f32 v[26:27], v[26:27], v[242:243] op_sel_hi:[1,0]
    v_pk_mul_f32 v[28:29], v[28:29], v[244:245] op_sel_hi:[1,0]
    v_pk_mul_f32 v[30:31], v[30:31], v[244:245] op_sel_hi:[1,0]
    v_pk_mul_f32 v[32:33], v[32:33], v[246:247] op_sel_hi:[1,0]
    v_pk_mul_f32 v[34:35], v[34:35], v[246:247] op_sel_hi:[1,0]
    v_pk_mul_f32 v[36:37], v[36:37], v[242:243] op_sel_hi:[1,0]
    v_pk_mul_f32 v[38:39], v[38:39], v[242:243] op_sel_hi:[1,0]
    v_pk_mul_f32 v[40:41], v[40:41], v[244:245] op_sel_hi:[1,0]
    v_pk_mul_f32 v[42:43], v[42:43], v[244:245] op_sel_hi:[1,0]
    v_pk_mul_f32 v[44:45], v[44:45], v[246:247] op_sel_hi:[1,0]
    v_pk_mul_f32 v[46:47], v[46:47], v[246:247] op_sel_hi:[1,0]
    v_pk_mul_f32 v[48:49], v[48:49], v[242:243] op_sel_hi:[1,0]
    v_pk_mul_f32 v[50:51], v[50:51], v[242:243] op_sel_hi:[1,0]
    v_pk_mul_f32 v[52:53], v[52:53], v[244:245] op_sel_hi:[1,0]
    v_pk_mul_f32 v[54:55], v[54:55], v[244:245] op_sel_hi:[1,0]
    v_pk_mul_f32 v[56:57], v[56:57], v[246:247] op_sel_hi:[1,0]
    v_pk_mul_f32 v[58:59], v[58:59], v[246:247] op_sel_hi:[1,0]
    v_pk_mul_f32 v[60:61], v[60:61], v[242:243] op_sel_hi:[1,0]
    v_pk_mul_f32 v[62:63], v[62:63], v[242:243] op_sel_hi:[1,0]
    v_pk_mul_f32 v[64:65], v[64:65], v[244:245] op_sel_hi:[1,0]
    v_pk_mul_f32 v[66:67], v[66:67], v[244:245] op_sel_hi:[1,0]
    v_pk_mul_f32 v[68:69], v[68:69], v[246:247] op_sel_hi:[1,0]
    v_pk_mul_f32 v[70:71], v[70:71], v[246:247] op_sel_hi:[1,0]
    v_pk_mul_f32 v[72:73], v[72:73], v[242:243] op_sel_hi:[1,0]
    v_pk_mul_f32 v[74:75], v[74:75], v[242:243] op_sel_hi:[1,0]
    v_pk_mul_f32 v[76:77], v[76:77], v[244:245] op_sel_hi:[1,0]
    v_pk_mul_f32 v[78:79], v[78:79], v[244:245] op_sel_hi:[1,0]
    v_pk_mul_f32 v[80:81], v[80:81], v[246:247] op_sel_hi:[1,0]
    v_pk_mul_f32 v[82:83], v[82:83], v[246:247] op_sel_hi:[1,0]
    v_pk_mul_f32 v[84:85], v[84:85], v[242:243] op_sel_hi:[1,0]
    v_pk_mul_f32 v[86:87], v[86:87], v[242:243] op_sel_hi:[1,0]
    v_pk_mul_f32 v[88:89], v[88:89], v[244:245] op_sel_hi:[1,0]
    v_pk_mul_f32 v[90:91], v[90:91], v[244:245] op_sel_hi:[1,0]
    v_pk_mul_f32 v[92:93], v[92:93], v[246:247] op_sel_hi:[1,0]
    v_pk_mul_f32 v[94:95], v[94:95], v[246:247] op_sel_hi:[1,0]
L_FAST:
    v_fma_f32 v100, v100, s62, v248
    v_fma_f32 v101, v101, s62, v248
    v_fma_f32 v102, v102, s62, v248
    v_fma_f32 v103, v103, s62, v248
    v_exp_f32 v100, v100
    v_exp_f32 v101, v101
    v_exp_f32 v102, v102
    v_exp_f32 v103, v103
    v_fma_f32 v124, v124, s62, v248
    v_fma_f32 v125, v125, s62, v248
    v_fma_f32 v126, v126, s62, v248
    v_fma_f32 v127, v127, s62, v248
    v_exp_f32 v124, v124
    v_exp_f32 v125, v125
    v_exp_f32 v126, v126
    v_exp_f32 v127, v127
    v_fma_f32 v108, v108, s62, v249
    v_fma_f32 v109, v109, s62, v249
    v_fma_f32 v110, v110, s62, v249
    v_fma_f32 v111, v111, s62, v249
    v_exp_f32 v108, v108
    v_exp_f32 v109, v109
    v_exp_f32 v110, v110
    v_exp_f32 v111, v111
    v_fma_f32 v132, v132, s62, v249
    v_fma_f32 v133, v133, s62, v249
    v_fma_f32 v134, v134, s62, v249
    v_fma_f32 v135, v135, s62, v249
    v_exp_f32 v132, v132
    v_exp_f32 v133, v133
    v_exp_f32 v134, v134
    v_exp_f32 v135, v135
    v_fma_f32 v116, v116, s62, v250
    v_fma_f32 v117, v117, s62, v250
    v_fma_f32 v118, v118, s62, v250
    v_fma_f32 v119, v119, s62, v250
    v_exp_f32 v116, v116
    v_exp_f32 v117, v117
    v_exp_f32 v118, v118
    v_exp_f32 v119, v119
    v_fma_f32 v140, v140, s62, v250
    v_fma_f32 v141, v141, s62, v250
    v_fma_f32 v142, v142, s62, v250
    v_fma_f32 v143, v143, s62, v250
    v_exp_f32 v140, v140
    v_exp_f32 v141, v141
    v_exp_f32 v142, v142
    v_exp_f32 v143, v143
    v_pk_add_f32 v[192:193], v[100:101], v[102:103]
    v_pk_add_f32 v[194:195], v[108:109], v[110:111]
    v_pk_add_f32 v[196:197], v[116:117], v[118:119]
    v_pk_add_f32 v[192:193], v[192:193], v[124:125]
    v_pk_add_f32 v[194:195], v[194:195], v[132:133]
    v_pk_add_f32 v[196:197], v[196:197], v[140:141]
    v_pk_add_f32 v[192:193], v[192:193], v[126:127]
    v_pk_add_f32 v[194:195], v[194:195], v[134:135]
    v_pk_add_f32 v[196:197], v[196:197], v[142:143]
    v_add_f32 v239, v239, v192
    v_add_f32 v240, v240, v194
    v_add_f32 v241, v241, v196
    v_add_f32 v239, v239, v193
    v_add_f32 v240, v240, v195
    v_add_f32 v241, v241, v197
    v_cvt_pk_bf16_f32 v100, v100, v101
    v_cvt_pk_bf16_f32 v101, v102, v103
    v_cvt_pk_bf16_f32 v102, v124, v125
    v_cvt_pk_bf16_f32 v103, v126, v127
    v_cvt_pk_bf16_f32 v108, v108, v109
    v_cvt_pk_bf16_f32 v109, v110, v111
    v_cvt_pk_bf16_f32 v110, v132, v133
    v_cvt_pk_bf16_f32 v111, v134, v135
    v_cvt_pk_bf16_f32 v116, v116, v117
    v_cvt_pk_bf16_f32 v117, v118, v119
    v_cvt_pk_bf16_f32 v118, v140, v141
    v_cvt_pk_bf16_f32 v119, v142, v143
    s_waitcnt vmcnt(0)
    s_barrier
    ds_read_b64_tr_b16 v[192:193], v228 offset:0
    ds_read_b64_tr_b16 v[194:195], v228 offset:4096
    ds_read_b64_tr_b16 v[196:197], v229 offset:0
    ds_read_b64_tr_b16 v[198:199], v229 offset:4096
    ds_read_b64_tr_b16 v[200:201], v230 offset:0
    ds_read_b64_tr_b16 v[202:203], v230 offset:4096
    ds_read_b64_tr_b16 v[204:205], v231 offset:0
    ds_read_b64_tr_b16 v[206:207], v231 offset:4096
    ds_read_b64_tr_b16 v[208:209], v232 offset:0
    ds_read_b64_tr_b16 v[210:211], v232 offset:4096
    ds_read_b64_tr_b16 v[212:213], v233 offset:0
    ds_read_b64_tr_b16 v[214:215], v233 offset:4096
    ds_read_b64_tr_b16 v[216:217], v234 offset:0
    ds_read_b64_tr_b16 v[218:219], v234 offset:4096
    v_fma_f32 v148, v148, s62, v248
    v_fma_f32 v149, v149, s62, v248
    v_fma_f32 v150, v150, s62, v248
    v_fma_f32 v151, v151, s62, v248
    v_exp_f32 v148, v148
    v_exp_f32 v149, v149
    v_exp_f32 v150, v150
    v_exp_f32 v151, v151
    v_fma_f32 v156, v156, s62, v249
    v_fma_f32 v157, v157, s62, v249
    v_fma_f32 v158, v158, s62, v249
    v_fma_f32 v159, v159, s62, v249
    v_exp_f32 v156, v156
    v_exp_f32 v157, v157
    v_exp_f32 v158, v158
    v_exp_f32 v159, v159
    v_fma_f32 v164, v164, s62, v250
    v_fma_f32 v165, v165, s62, v250
    v_fma_f32 v166, v166, s62, v250
    v_fma_f32 v167, v167, s62, v250
    v_exp_f32 v164, v164
    v_exp_f32 v165, v165
    s_waitcnt lgkmcnt(12)
    v_mfma_f32_16x16x32_bf16 v[0:3], v[192:195], v[100:103], v[0:3]
    ds_read_b64_tr_b16 v[220:221], v235 offset:0
    v_exp_f32 v166, v166
    v_mfma_f32_16x16x32_bf16 v[4:7], v[192:195], v[108:111], v[4:7]
    ds_read_b64_tr_b16 v[222:223], v235 offset:4096
    v_exp_f32 v167, v167
    v_mfma_f32_16x16x32_bf16 v[8:11], v[192:195], v[116:119], v[8:11]
    v_fma_f32 v172, v172, s62, v248
    v_fma_f32 v173, v173, s62, v248
    s_waitcnt lgkmcnt(12)
    v_mfma_f32_16x16x32_bf16 v[12:15], v[196:199], v[100:103], v[12:15]
    ds_read_b64_tr_b16 v[192:193], v228 offset:8192
    v_fma_f32 v174, v174, s62, v248
    v_fma_f32 v175, v175, s62, v248
    v_mfma_f32_16x16x32_bf16 v[16:19], v[196:199], v[108:111], v[16:19]
    ds_read_b64_tr_b16 v[194:195], v228 offset:12288
    v_exp_f32 v172, v172
    v_mfma_f32_16x16x32_bf16 v[20:23], v[196:199], v[116:119], v[20:23]
    v_exp_f32 v173, v173
    s_waitcnt lgkmcnt(12)
    v_mfma_f32_16x16x32_bf16 v[24:27], v[200:203], v[100:103], v[24:27]
    ds_read_b64_tr_b16 v[196:197], v229 offset:8192
    v_exp_f32 v174, v174
    v_mfma_f32_16x16x32_bf16 v[28:31], v[200:203], v[108:111], v[28:31]
    ds_read_b64_tr_b16 v[198:199], v229 offset:12288
    v_exp_f32 v175, v175
    v_mfma_f32_16x16x32_bf16 v[32:35], v[200:203], v[116:119], v[32:35]
    v_fma_f32 v180, v180, s62, v249
    v_fma_f32 v181, v181, s62, v249
    s_waitcnt lgkmcnt(12)
    v_mfma_f32_16x16x32_bf16 v[36:39], v[204:207], v[100:103], v[36:39]
    ds_read_b64_tr_b16 v[200:201], v230 offset:8192
    v_fma_f32 v182, v182, s62, v249
    v_fma_f32 v183, v183, s62, v249
    v_mfma_f32_16x16x32_bf16 v[40:43], v[204:207], v[108:111], v[40:43]
    ds_read_b64_tr_b16 v[202:203], v230 offset:12288
    v_exp_f32 v180, v180
    v_mfma_f32_16x16x32_bf16 v[44:47], v[204:207], v[116:119], v[44:47]
    v_exp_f32 v181, v181
    s_waitcnt lgkmcnt(12)
    v_mfma_f32_16x16x32_bf16 v[48:51], v[208:211], v[100:103], v[48:51]
    ds_read_b64_tr_b16 v[204:205], v231 offset:8192
    v_exp_f32 v182, v182
    v_mfma_f32_16x16x32_bf16 v[52:55], v[208:211], v[108:111], v[52:55]
    ds_read_b64_tr_b16 v[206:207], v231 offset:12288
    v_exp_f32 v183, v183
    v_mfma_f32_16x16x32_bf16 v[56:59], v[208:211], v[116:119], v[56:59]
    v_fma_f32 v188, v188, s62, v250
    v_fma_f32 v189, v189, s62, v250
    s_waitcnt lgkmcnt(12)
    v_mfma_f32_16x16x32_bf16 v[60:63], v[212:215], v[100:103], v[60:63]
    ds_read_b64_tr_b16 v[208:209], v232 offset:8192
    v_fma_f32 v190, v190, s62, v250
    v_fma_f32 v191, v191, s62, v250
    v_mfma_f32_16x16x32_bf16 v[64:67], v[212:215], v[108:111], v[64:67]
    ds_read_b64_tr_b16 v[210:211], v232 offset:12288
    v_exp_f32 v188, v188
    v_mfma_f32_16x16x32_bf16 v[68:71], v[212:215], v[116:119], v[68:71]
    v_exp_f32 v189, v189
    s_waitcnt lgkmcnt(12)
    v_mfma_f32_16x16x32_bf16 v[72:75], v[216:219], v[100:103], v[72:75]
    ds_read_b64_tr_b16 v[212:213], v233 offset:8192
    v_exp_f32 v190, v190
    v_mfma_f32_16x16x32_bf16 v[76:79], v[216:219], v[108:111], v[76:79]
    ds_read_b64_tr_b16 v[214:215], v233 offset:12288
    v_exp_f32 v191, v191
    v_mfma_f32_16x16x32_bf16 v[80:83], v[216:219], v[116:119], v[80:83]
    v_add_f32 v239, v239, v148
    v_add_f32 v240, v240, v156
    s_waitcnt lgkmcnt(12)
    v_mfma_f32_16x16x32_bf16 v[84:87], v[220:223], v[100:103], v[84:87]
    ds_read_b64_tr_b16 v[216:217], v234 offset:8192
    v_add_f32 v241, v241, v164
    v_add_f32 v239, v239, v149
    v_mfma_f32_16x16x32_bf16 v[88:91], v[220:223], v[108:111], v[88:91]
    ds_read_b64_tr_b16 v[218:219], v234 offset:12288
    v_add_f32 v240, v240, v157
    v_add_f32 v241, v241, v165
    v_mfma_f32_16x16x32_bf16 v[92:95], v[220:223], v[116:119], v[92:95]
    v_add_f32 v239, v239, v150
    v_add_f32 v240, v240, v158
    v_add_f32 v241, v241, v166
    v_add_f32 v239, v239, v151
    v_add_f32 v240, v240, v159
    v_add_f32 v241, v241, v167
    v_add_f32 v239, v239, v172
    v_add_f32 v240, v240, v180
    v_add_f32 v241, v241, v188
    v_add_f32 v239, v239, v173
    v_add_f32 v240, v240, v181
    v_add_f32 v241, v241, v189
    v_add_f32 v239, v239, v174
    v_add_f32 v240, v240, v182
    v_add_f32 v241, v241, v190
    v_add_f32 v239, v239, v175
    v_add_f32 v240, v240, v183
    v_add_f32 v241, v241, v191
    v_cvt_pk_bf16_f32 v148, v148, v149
    v_cvt_pk_bf16_f32 v149, v150, v151
    v_cvt_pk_bf16_f32 v150, v172, v173
    v_cvt_pk_bf16_f32 v151, v174, v175
    v_cvt_pk_bf16_f32 v156, v156, v157
    v_cvt_pk_bf16_f32 v157, v158, v159
    v_cvt_pk_bf16_f32 v158, v180, v181
    v_cvt_pk_bf16_f32 v159, v182, v183
    v_cvt_pk_bf16_f32 v164, v164, v165
    v_cvt_pk_bf16_f32 v165, v166, v167
    v_cvt_pk_bf16_f32 v166, v188, v189
    v_cvt_pk_bf16_f32 v167, v190, v191
    s_nop 1
    s_waitcnt lgkmcnt(12)
    v_mfma_f32_16x16x32_bf16 v[0:3], v[192:195], v[148:151], v[0:3]
    ds_read_b64_tr_b16 v[220:221], v235 offset:8192
    v_mfma_f32_16x16x32_bf16 v[4:7], v[192:195], v[156:159], v[4:7]
    ds_read_b64_tr_b16 v[222:223], v235 offset:12288
    v_mfma_f32_16x16x32_bf16 v[8:11], v[192:195], v[164:167], v[8:11]
    s_waitcnt lgkmcnt(12)
    v_mfma_f32_16x16x32_bf16 v[12:15], v[196:199], v[148:151], v[12:15]
    v_mfma_f32_16x16x32_bf16 v[16:19], v[196:199], v[156:159], v[16:19]
    v_mfma_f32_16x16x32_bf16 v[20:23], v[196:199], v[164:167], v[20:23]
    s_waitcnt lgkmcnt(10)
    v_mfma_f32_16x16x32_bf16 v[24:27], v[200:203], v[148:151], v[24:27]
    v_mfma_f32_16x16x32_bf16 v[28:31], v[200:203], v[156:159], v[28:31]
    v_mfma_f32_16x16x32_bf16 v[32:35], v[200:203], v[164:167], v[32:35]
    s_waitcnt lgkmcnt(8)
    v_mfma_f32_16x16x32_bf16 v[36:39], v[204:207], v[148:151], v[36:39]
    v_mfma_f32_16x16x32_bf16 v[40:43], v[204:207], v[156:159], v[40:43]
    v_mfma_f32_16x16x32_bf16 v[44:47], v[204:207], v[164:167], v[44:47]
    s_waitcnt lgkmcnt(6)
    v_mfma_f32_16x16x32_bf16 v[48:51], v[208:211], v[148:151], v[48:51]
    v_mfma_f32_16x16x32_bf16 v[52:55], v[208:211], v[156:159], v[52:55]
    v_mfma_f32_16x16x32_bf16 v[56:59], v[208:211], v[164:167], v[56:59]
    s_waitcnt lgkmcnt(4)
    v_mfma_f32_16x16x32_bf16 v[60:63], v[212:215], v[148:151], v[60:63]
    v_mfma_f32_16x16x32_bf16 v[64:67], v[212:215], v[156:159], v[64:67]
    v_mfma_f32_16x16x32_bf16 v[68:71], v[212:215], v[164:167], v[68:71]
    s_waitcnt lgkmcnt(2)
    v_mfma_f32_16x16x32_bf16 v[72:75], v[216:219], v[148:151], v[72:75]
    v_mfma_f32_16x16x32_bf16 v[76:79], v[216:219], v[156:159], v[76:79]
    v_mfma_f32_16x16x32_bf16 v[80:83], v[216:219], v[164:167], v[80:83]
    s_waitcnt lgkmcnt(0)
    v_mfma_f32_16x16x32_bf16 v[84:87], v[220:223], v[148:151], v[84:87]
    v_mfma_f32_16x16x32_bf16 v[88:91], v[220:223], v[156:159], v[88:91]
    v_mfma_f32_16x16x32_bf16 v[92:95], v[220:223], v[164:167], v[92:95]
    s_sub_u32 s64, s64, 1
    s_cmp_lg_u32 s64, 0
    s_cbranch_scc1 L_ATT
    v_mov_b32 v251, v239
    v_mov_b32 v252, v240
    v_mov_b32 v253, v241
    s_nop 0
    v_permlane16_swap_b32 v239, v251
    v_permlane16_swap_b32 v240, v252
    v_permlane16_swap_b32 v241, v253
    s_nop 0
    v_add_f32 v239, v239, v251
    v_add_f32 v240, v240, v252
    v_add_f32 v241, v241, v253
    v_mov_b32 v251, v239
    v_mov_b32 v252, v240
    v_mov_b32 v253, v241
    s_nop 0
    v_permlane32_swap_b32 v239, v251
    v_permlane32_swap_b32 v240, v252
    v_permlane32_swap_b32 v241, v253
    s_nop 0
    v_add_f32 v239, v239, v251
    v_add_f32 v240, v240, v252
    v_add_f32 v241, v241, v253
    v_rcp_f32 v242, v239
    v_rcp_f32 v244, v240
    v_rcp_f32 v246, v241
    s_nop 0
    v_mbcnt_lo_u32_b32 v251, -1, 0
    v_mbcnt_hi_u32_b32 v251, -1, v251
    v_lshlrev_b32 v251, 4, v251
    s_mul_i32 s7, s3, 12288
    s_add_u32 s7, s7, 49152
    v_add_u32 v252, s7, v251
    s_xor_b32 s18, s3, 1
    s_mul_i32 s18, s18, 12288
    s_add_u32 s18, s18, 49152
    v_add_u32 v253, s18, v251
    s_mul_i32 s7, s3, 24576
    v_add_u32 v255, s7, v251
    v_pk_mul_f32 v[0:1], v[0:1], v[242:243] op_sel_hi:[1,0]
    v_pk_mul_f32 v[2:3], v[2:3], v[242:243] op_sel_hi:[1,0]
    v_pk_mul_f32 v[12:13], v[12:13], v[242:243] op_sel_hi:[1,0]
    v_pk_mul_f32 v[14:15], v[14:15], v[242:243] op_sel_hi:[1,0]
    v_cvt_pk_bf16_f32 v96, v0, v1
    v_cvt_pk_bf16_f32 v97, v2, v3
    v_cvt_pk_bf16_f32 v98, v12, v13
    v_cvt_pk_bf16_f32 v99, v14, v15
    ds_write_b128 v252, v[96:99] offset:0
    v_pk_mul_f32 v[4:5], v[4:5], v[244:245] op_sel_hi:[1,0]
    v_pk_mul_f32 v[6:7], v[6:7], v[244:245] op_sel_hi:[1,0]
    v_pk_mul_f32 v[16:17], v[16:17], v[244:245] op_sel_hi:[1,0]
    v_pk_mul_f32 v[18:19], v[18:19], v[244:245] op_sel_hi:[1,0]
    v_cvt_pk_bf16_f32 v104, v4, v5
    v_cvt_pk_bf16_f32 v105, v6, v7
    v_cvt_pk_bf16_f32 v106, v16, v17
    v_cvt_pk_bf16_f32 v107, v18, v19
    ds_write_b128 v252, v[104:107] offset:1024
    v_pk_mul_f32 v[8:9], v[8:9], v[246:247] op_sel_hi:[1,0]
    v_pk_mul_f32 v[10:11], v[10:11], v[246:247] op_sel_hi:[1,0]
    v_pk_mul_f32 v[20:21], v[20:21], v[246:247] op_sel_hi:[1,0]
    v_pk_mul_f32 v[22:23], v[22:23], v[246:247] op_sel_hi:[1,0]
    v_cvt_pk_bf16_f32 v112, v8, v9
    v_cvt_pk_bf16_f32 v113, v10, v11
    v_cvt_pk_bf16_f32 v114, v20, v21
    v_cvt_pk_bf16_f32 v115, v22, v23
    ds_write_b128 v252, v[112:115] offset:2048
    v_pk_mul_f32 v[24:25], v[24:25], v[242:243] op_sel_hi:[1,0]
    v_pk_mul_f32 v[26:27], v[26:27], v[242:243] op_sel_hi:[1,0]
    v_pk_mul_f32 v[36:37], v[36:37], v[242:243] op_sel_hi:[1,0]
    v_pk_mul_f32 v[38:39], v[38:39], v[242:243] op_sel_hi:[1,0]
    v_cvt_pk_bf16_f32 v120, v24, v25
    v_cvt_pk_bf16_f32 v121, v26, v27
    v_cvt_pk_bf16_f32 v122, v36, v37
    v_cvt_pk_bf16_f32 v123, v38, v39
    ds_write_b128 v252, v[120:123] offset:3072
    v_pk_mul_f32 v[28:29], v[28:29], v[244:245] op_sel_hi:[1,0]
    v_pk_mul_f32 v[30:31], v[30:31], v[244:245] op_sel_hi:[1,0]
    v_pk_mul_f32 v[40:41], v[40:41], v[244:245] op_sel_hi:[1,0]
    v_pk_mul_f32 v[42:43], v[42:43], v[244:245] op_sel_hi:[1,0]
    v_cvt_pk_bf16_f32 v128, v28, v29
    v_cvt_pk_bf16_f32 v129, v30, v31
    v_cvt_pk_bf16_f32 v130, v40, v41
    v_cvt_pk_bf16_f32 v131, v42, v43
    ds_write_b128 v252, v[128:131] offset:4096
    v_pk_mul_f32 v[32:33], v[32:33], v[246:247] op_sel_hi:[1,0]
    v_pk_mul_f32 v[34:35], v[34:35], v[246:247] op_sel_hi:[1,0]
    v_pk_mul_f32 v[44:45], v[44:45], v[246:247] op_sel_hi:[1,0]
    v_pk_mul_f32 v[46:47], v[46:47], v[246:247] op_sel_hi:[1,0]
    v_cvt_pk_bf16_f32 v136, v32, v33
    v_cvt_pk_bf16_f32 v137, v34, v35
    v_cvt_pk_bf16_f32 v138, v44, v45
    v_cvt_pk_bf16_f32 v139, v46, v47
    ds_write_b128 v252, v[136:139] offset:5120
    v_pk_mul_f32 v[48:49], v[48:49], v[242:243] op_sel_hi:[1,0]
    v_pk_mul_f32 v[50:51], v[50:51], v[242:243] op_sel_hi:[1,0]
    v_pk_mul_f32 v[60:61], v[60:61], v[242:243] op_sel_hi:[1,0]
    v_pk_mul_f32 v[62:63], v[62:63], v[242:243] op_sel_hi:[1,0]
    v_cvt_pk_bf16_f32 v144, v48, v49
    v_cvt_pk_bf16_f32 v145, v50, v51
    v_cvt_pk_bf16_f32 v146, v60, v61
    v_cvt_pk_bf16_f32 v147, v62, v63
    ds_write_b128 v252, v[144:147] offset:6144
    v_pk_mul_f32 v[52:53], v[52:53], v[244:245] op_sel_hi:[1,0]
    v_pk_mul_f32 v[54:55], v[54:55], v[244:245] op_sel_hi:[1,0]
    v_pk_mul_f32 v[64:65], v[64:65], v[244:245] op_sel_hi:[1,0]
    v_pk_mul_f32 v[66:67], v[66:67], v[244:245] op_sel_hi:[1,0]
    v_cvt_pk_bf16_f32 v152, v52, v53
    v_cvt_pk_bf16_f32 v153, v54, v55
    v_cvt_pk_bf16_f32 v154, v64, v65
    v_cvt_pk_bf16_f32 v155, v66, v67
    ds_write_b128 v252, v[152:155] offset:7168
    v_pk_mul_f32 v[56:57], v[56:57], v[246:247] op_sel_hi:[1,0]
    v_pk_mul_f32 v[58:59], v[58:59], v[246:247] op_sel_hi:[1,0]
    v_pk_mul_f32 v[68:69], v[68:69], v[246:247] op_sel_hi:[1,0]
    v_pk_mul_f32 v[70:71], v[70:71], v[246:247] op_sel_hi:[1,0]
    v_cvt_pk_bf16_f32 v160, v56, v57
    v_cvt_pk_bf16_f32 v161, v58, v59
    v_cvt_pk_bf16_f32 v162, v68, v69
    v_cvt_pk_bf16_f32 v163, v70, v71
    ds_write_b128 v252, v[160:163] offset:8192
    v_pk_mul_f32 v[72:73], v[72:73], v[242:243] op_sel_hi:[1,0]
    v_pk_mul_f32 v[74:75], v[74:75], v[242:243] op_sel_hi:[1,0]
    v_pk_mul_f32 v[84:85], v[84:85], v[242:243] op_sel_hi:[1,0]
    v_pk_mul_f32 v[86:87], v[86:87], v[242:243] op_sel_hi:[1,0]
    v_cvt_pk_bf16_f32 v168, v72, v73
    v_cvt_pk_bf16_f32 v169, v74, v75
    v_cvt_pk_bf16_f32 v170, v84, v85
    v_cvt_pk_bf16_f32 v171, v86, v87
    ds_write_b128 v252, v[168:171] offset:9216
    v_pk_mul_f32 v[76:77], v[76:77], v[244:245] op_sel_hi:[1,0]
    v_pk_mul_f32 v[78:79], v[78:79], v[244:245] op_sel_hi:[1,0]
    v_pk_mul_f32 v[88:89], v[88:89], v[244:245] op_sel_hi:[1,0]
    v_pk_mul_f32 v[90:91], v[90:91], v[244:245] op_sel_hi:[1,0]
    v_cvt_pk_bf16_f32 v176, v76, v77
    v_cvt_pk_bf16_f32 v177, v78, v79
    v_cvt_pk_bf16_f32 v178, v88, v89
    v_cvt_pk_bf16_f32 v179, v90, v91
    ds_write_b128 v252, v[176:179] offset:10240
    v_pk_mul_f32 v[80:81], v[80:81], v[246:247] op_sel_hi:[1,0]
    v_pk_mul_f32 v[82:83], v[82:83], v[246:247] op_sel_hi:[1,0]
    v_pk_mul_f32 v[92:93], v[92:93], v[246:247] op_sel_hi:[1,0]
    v_pk_mul_f32 v[94:95], v[94:95], v[246:247] op_sel_hi:[1,0]
    v_cvt_pk_bf16_f32 v184, v80, v81
    v_cvt_pk_bf16_f32 v185, v82, v83
    v_cvt_pk_bf16_f32 v186, v92, v93
    v_cvt_pk_bf16_f32 v187, v94, v95
    ds_write_b128 v252, v[184:187] offset:11264
    s_waitcnt lgkmcnt(0)
    s_barrier
    ds_read_b128 v[100:103], v253 offset:0
    ds_read_b128 v[108:111], v253 offset:1024
    ds_read_b128 v[116:119], v253 offset:2048
    ds_read_b128 v[124:127], v253 offset:3072
    ds_read_b128 v[132:135], v253 offset:4096
    ds_read_b128 v[140:143], v253 offset:5120
    ds_read_b128 v[148:151], v253 offset:6144
    ds_read_b128 v[156:159], v253 offset:7168
    ds_read_b128 v[164:167], v253 offset:8192
    ds_read_b128 v[172:175], v253 offset:9216
    ds_read_b128 v[180:183], v253 offset:10240
    ds_read_b128 v[188:191], v253 offset:11264
    s_waitcnt lgkmcnt(0)
    v_add_u32 v228, s68, v227
    v_xor_b32 v229, 32, v228
    v_xor_b32 v230, 64, v228
    v_xor_b32 v231, 96, v228
    v_add_u32 v232, s69, v227
    v_xor_b32 v233, 32, v232
    v_xor_b32 v234, 64, v232
    v_xor_b32 v235, 96, v232
    s_barrier
    ds_read_b64_tr_b16 v[192:193], v228 offset:0
    ds_read_b64_tr_b16 v[194:195], v228 offset:2048
    ds_read_b64_tr_b16 v[196:197], v229 offset:0
    ds_read_b64_tr_b16 v[198:199], v229 offset:2048
    ds_read_b64_tr_b16 v[200:201], v230 offset:0
    ds_read_b64_tr_b16 v[202:203], v230 offset:2048
    ds_read_b64_tr_b16 v[204:205], v231 offset:0
    ds_read_b64_tr_b16 v[206:207], v231 offset:2048
    ds_read_b64_tr_b16 v[208:209], v228 offset:4096
    ds_read_b64_tr_b16 v[210:211], v228 offset:6144
    ds_read_b64_tr_b16 v[212:213], v229 offset:4096
    ds_read_b64_tr_b16 v[214:215], v229 offset:6144
    ds_read_b64_tr_b16 v[216:217], v230 offset:4096
    ds_read_b64_tr_b16 v[218:219], v230 offset:6144
    s_waitcnt lgkmcnt(12)
    v_mfma_f32_16x16x32_bf16 v[0:3], v[192:195], v[96:99], 0
    ds_read_b64_tr_b16 v[220:221], v231 offset:4096
    v_mfma_f32_16x16x32_bf16 v[8:11], v[192:195], v[104:107], 0
    ds_read_b64_tr_b16 v[222:223], v231 offset:6144
    v_mfma_f32_16x16x32_bf16 v[16:19], v[192:195], v[112:115], 0
    s_waitcnt lgkmcnt(12)
    v_mfma_f32_16x16x32_bf16 v[4:7], v[196:199], v[96:99], 0
    ds_read_b64_tr_b16 v[192:193], v228 offset:8192
    v_mfma_f32_16x16x32_bf16 v[12:15], v[196:199], v[104:107], 0
    ds_read_b64_tr_b16 v[194:195], v228 offset:10240
    v_mfma_f32_16x16x32_bf16 v[20:23], v[196:199], v[112:115], 0
    s_waitcnt lgkmcnt(12)
    v_mfma_f32_16x16x32_bf16 v[24:27], v[200:203], v[96:99], 0
    ds_read_b64_tr_b16 v[196:197], v229 offset:8192
    v_mfma_f32_16x16x32_bf16 v[32:35], v[200:203], v[104:107], 0
    ds_read_b64_tr_b16 v[198:199], v229 offset:10240
    v_mfma_f32_16x16x32_bf16 v[40:43], v[200:203], v[112:115], 0
    s_waitcnt lgkmcnt(12)
    v_mfma_f32_16x16x32_bf16 v[28:31], v[204:207], v[96:99], 0
    ds_read_b64_tr_b16 v[200:201], v230 offset:8192
    v_mfma_f32_16x16x32_bf16 v[36:39], v[204:207], v[104:107], 0
    ds_read_b64_tr_b16 v[202:203], v230 offset:10240
    v_mfma_f32_16x16x32_bf16 v[44:47], v[204:207], v[112:115], 0
    s_waitcnt lgkmcnt(12)
    v_mfma_f32_16x16x32_bf16 v[0:3], v[208:211], v[120:123], v[0:3]
    ds_read_b64_tr_b16 v[204:205], v231 offset:8192
    v_mfma_f32_16x16x32_bf16 v[8:11], v[208:211], v[128:131], v[8:11]
    ds_read_b64_tr_b16 v[206:207], v231 offset:10240
    v_mfma_f32_16x16x32_bf16 v[16:19], v[208:211], v[136:139], v[16:19]
    s_waitcnt lgkmcnt(12)
    v_mfma_f32_16x16x32_bf16 v[4:7], v[212:215], v[120:123], v[4:7]
    ds_read_b64_tr_b16 v[208:209], v228 offset:12288
    v_mfma_f32_16x16x32_bf16 v[12:15], v[212:215], v[128:131], v[12:15]
    ds_read_b64_tr_b16 v[210:211], v228 offset:14336
    v_mfma_f32_16x16x32_bf16 v[20:23], v[212:215], v[136:139], v[20:23]
    s_waitcnt lgkmcnt(12)
    v_mfma_f32_16x16x32_bf16 v[24:27], v[216:219], v[120:123], v[24:27]
    ds_read_b64_tr_b16 v[212:213], v229 offset:12288
    v_mfma_f32_16x16x32_bf16 v[32:35], v[216:219], v[128:131], v[32:35]
    ds_read_b64_tr_b16 v[214:215], v229 offset:14336
    v_mfma_f32_16x16x32_bf16 v[40:43], v[216:219], v[136:139], v[40:43]
    s_waitcnt lgkmcnt(12)
    v_mfma_f32_16x16x32_bf16 v[28:31], v[220:223], v[120:123], v[28:31]
    ds_read_b64_tr_b16 v[216:217], v230 offset:12288
    v_mfma_f32_16x16x32_bf16 v[36:39], v[220:223], v[128:131], v[36:39]
    ds_read_b64_tr_b16 v[218:219], v230 offset:14336
    v_mfma_f32_16x16x32_bf16 v[44:47], v[220:223], v[136:139], v[44:47]
    s_waitcnt lgkmcnt(12)
    v_mfma_f32_16x16x32_bf16 v[0:3], v[192:195], v[144:147], v[0:3]
    ds_read_b64_tr_b16 v[220:221], v231 offset:12288
    v_mfma_f32_16x16x32_bf16 v[8:11], v[192:195], v[152:155], v[8:11]
    ds_read_b64_tr_b16 v[222:223], v231 offset:14336
    v_mfma_f32_16x16x32_bf16 v[16:19], v[192:195], v[160:163], v[16:19]
    s_waitcnt lgkmcnt(12)
    v_mfma_f32_16x16x32_bf16 v[4:7], v[196:199], v[144:147], v[4:7]
    ds_read_b64_tr_b16 v[192:193], v232 offset:0
    v_mfma_f32_16x16x32_bf16 v[12:15], v[196:199], v[152:155], v[12:15]
    ds_read_b64_tr_b16 v[194:195], v232 offset:2048
    v_mfma_f32_16x16x32_bf16 v[20:23], v[196:199], v[160:163], v[20:23]
    s_waitcnt lgkmcnt(12)
    v_mfma_f32_16x16x32_bf16 v[24:27], v[200:203], v[144:147], v[24:27]
    ds_read_b64_tr_b16 v[196:197], v233 offset:0
    v_mfma_f32_16x16x32_bf16 v[32:35], v[200:203], v[152:155], v[32:35]
    ds_read_b64_tr_b16 v[198:199], v233 offset:2048
    v_mfma_f32_16x16x32_bf16 v[40:43], v[200:203], v[160:163], v[40:43]
    s_waitcnt lgkmcnt(12)
    v_mfma_f32_16x16x32_bf16 v[28:31], v[204:207], v[144:147], v[28:31]
    ds_read_b64_tr_b16 v[200:201], v234 offset:0
    v_mfma_f32_16x16x32_bf16 v[36:39], v[204:207], v[152:155], v[36:39]
    ds_read_b64_tr_b16 v[202:203], v234 offset:2048
    v_mfma_f32_16x16x32_bf16 v[44:47], v[204:207], v[160:163], v[44:47]
    s_waitcnt lgkmcnt(12)
    v_mfma_f32_16x16x32_bf16 v[0:3], v[208:211], v[168:171], v[0:3]
    ds_read_b64_tr_b16 v[204:205], v235 offset:0
    v_mfma_f32_16x16x32_bf16 v[8:11], v[208:211], v[176:179], v[8:11]
    ds_read_b64_tr_b16 v[206:207], v235 offset:2048
    v_mfma_f32_16x16x32_bf16 v[16:19], v[208:211], v[184:187], v[16:19]
    s_waitcnt lgkmcnt(12)
    v_mfma_f32_16x16x32_bf16 v[4:7], v[212:215], v[168:171], v[4:7]
    ds_read_b64_tr_b16 v[208:209], v232 offset:4096
    v_mfma_f32_16x16x32_bf16 v[12:15], v[212:215], v[176:179], v[12:15]
    ds_read_b64_tr_b16 v[210:211], v232 offset:6144
    v_mfma_f32_16x16x32_bf16 v[20:23], v[212:215], v[184:187], v[20:23]
    s_waitcnt lgkmcnt(12)
    v_mfma_f32_16x16x32_bf16 v[24:27], v[216:219], v[168:171], v[24:27]
    ds_read_b64_tr_b16 v[212:213], v233 offset:4096
    v_mfma_f32_16x16x32_bf16 v[32:35], v[216:219], v[176:179], v[32:35]
    ds_read_b64_tr_b16 v[214:215], v233 offset:6144
    v_mfma_f32_16x16x32_bf16 v[40:43], v[216:219], v[184:187], v[40:43]
    s_waitcnt lgkmcnt(12)
    v_mfma_f32_16x16x32_bf16 v[28:31], v[220:223], v[168:171], v[28:31]
    ds_read_b64_tr_b16 v[216:217], v234 offset:4096
    v_mfma_f32_16x16x32_bf16 v[36:39], v[220:223], v[176:179], v[36:39]
    ds_read_b64_tr_b16 v[218:219], v234 offset:6144
    v_mfma_f32_16x16x32_bf16 v[44:47], v[220:223], v[184:187], v[44:47]
    s_waitcnt lgkmcnt(12)
    v_mfma_f32_16x16x32_bf16 v[0:3], v[192:195], v[100:103], v[0:3]
    ds_read_b64_tr_b16 v[220:221], v235 offset:4096
    v_mfma_f32_16x16x32_bf16 v[8:11], v[192:195], v[108:111], v[8:11]
    ds_read_b64_tr_b16 v[222:223], v235 offset:6144
    v_mfma_f32_16x16x32_bf16 v[16:19], v[192:195], v[116:119], v[16:19]
    s_waitcnt lgkmcnt(12)
    v_mfma_f32_16x16x32_bf16 v[4:7], v[196:199], v[100:103], v[4:7]
    ds_read_b64_tr_b16 v[192:193], v232 offset:8192
    v_mfma_f32_16x16x32_bf16 v[12:15], v[196:199], v[108:111], v[12:15]
    ds_read_b64_tr_b16 v[194:195], v232 offset:10240
    v_mfma_f32_16x16x32_bf16 v[20:23], v[196:199], v[116:119], v[20:23]
    s_waitcnt lgkmcnt(12)
    v_mfma_f32_16x16x32_bf16 v[24:27], v[200:203], v[100:103], v[24:27]
    ds_read_b64_tr_b16 v[196:197], v233 offset:8192
    v_mfma_f32_16x16x32_bf16 v[32:35], v[200:203], v[108:111], v[32:35]
    ds_read_b64_tr_b16 v[198:199], v233 offset:10240
    v_mfma_f32_16x16x32_bf16 v[40:43], v[200:203], v[116:119], v[40:43]
    s_waitcnt lgkmcnt(12)
    v_mfma_f32_16x16x32_bf16 v[28:31], v[204:207], v[100:103], v[28:31]
    ds_read_b64_tr_b16 v[200:201], v234 offset:8192
    v_mfma_f32_16x16x32_bf16 v[36:39], v[204:207], v[108:111], v[36:39]
    ds_read_b64_tr_b16 v[202:203], v234 offset:10240
    v_mfma_f32_16x16x32_bf16 v[44:47], v[204:207], v[116:119], v[44:47]
    s_waitcnt lgkmcnt(12)
    v_mfma_f32_16x16x32_bf16 v[0:3], v[208:211], v[124:127], v[0:3]
    ds_read_b64_tr_b16 v[204:205], v235 offset:8192
    v_mfma_f32_16x16x32_bf16 v[8:11], v[208:211], v[132:135], v[8:11]
    ds_read_b64_tr_b16 v[206:207], v235 offset:10240
    v_mfma_f32_16x16x32_bf16 v[16:19], v[208:211], v[140:143], v[16:19]
    s_waitcnt lgkmcnt(12)
    v_mfma_f32_16x16x32_bf16 v[4:7], v[212:215], v[124:127], v[4:7]
    ds_read_b64_tr_b16 v[208:209], v232 offset:12288
    v_mfma_f32_16x16x32_bf16 v[12:15], v[212:215], v[132:135], v[12:15]
    ds_read_b64_tr_b16 v[210:211], v232 offset:14336
    v_mfma_f32_16x16x32_bf16 v[20:23], v[212:215], v[140:143], v[20:23]
    s_waitcnt lgkmcnt(12)
    v_mfma_f32_16x16x32_bf16 v[24:27], v[216:219], v[124:127], v[24:27]
    ds_read_b64_tr_b16 v[212:213], v233 offset:12288
    v_mfma_f32_16x16x32_bf16 v[32:35], v[216:219], v[132:135], v[32:35]
    ds_read_b64_tr_b16 v[214:215], v233 offset:14336
    v_mfma_f32_16x16x32_bf16 v[40:43], v[216:219], v[140:143], v[40:43]
    s_waitcnt lgkmcnt(12)
    v_mfma_f32_16x16x32_bf16 v[28:31], v[220:223], v[124:127], v[28:31]
    ds_read_b64_tr_b16 v[216:217], v234 offset:12288
    v_mfma_f32_16x16x32_bf16 v[36:39], v[220:223], v[132:135], v[36:39]
    ds_read_b64_tr_b16 v[218:219], v234 offset:14336
    v_mfma_f32_16x16x32_bf16 v[44:47], v[220:223], v[140:143], v[44:47]
    s_waitcnt lgkmcnt(12)
    v_mfma_f32_16x16x32_bf16 v[0:3], v[192:195], v[148:151], v[0:3]
    ds_read_b64_tr_b16 v[220:221], v235 offset:12288
    v_mfma_f32_16x16x32_bf16 v[8:11], v[192:195], v[156:159], v[8:11]
    ds_read_b64_tr_b16 v[222:223], v235 offset:14336
    v_mfma_f32_16x16x32_bf16 v[16:19], v[192:195], v[164:167], v[16:19]
    s_waitcnt lgkmcnt(12)
    v_mfma_f32_16x16x32_bf16 v[4:7], v[196:199], v[148:151], v[4:7]
    v_mfma_f32_16x16x32_bf16 v[12:15], v[196:199], v[156:159], v[12:15]
    v_mfma_f32_16x16x32_bf16 v[20:23], v[196:199], v[164:167], v[20:23]
    s_waitcnt lgkmcnt(10)
    v_mfma_f32_16x16x32_bf16 v[24:27], v[200:203], v[148:151], v[24:27]
    v_mfma_f32_16x16x32_bf16 v[32:35], v[200:203], v[156:159], v[32:35]
    v_mfma_f32_16x16x32_bf16 v[40:43], v[200:203], v[164:167], v[40:43]
    s_waitcnt lgkmcnt(8)
    v_mfma_f32_16x16x32_bf16 v[28:31], v[204:207], v[148:151], v[28:31]
    v_mfma_f32_16x16x32_bf16 v[36:39], v[204:207], v[156:159], v[36:39]
    v_mfma_f32_16x16x32_bf16 v[44:47], v[204:207], v[164:167], v[44:47]
    s_waitcnt lgkmcnt(6)
    v_mfma_f32_16x16x32_bf16 v[0:3], v[208:211], v[172:175], v[0:3]
    v_mfma_f32_16x16x32_bf16 v[8:11], v[208:211], v[180:183], v[8:11]
    v_mfma_f32_16x16x32_bf16 v[16:19], v[208:211], v[188:191], v[16:19]
    s_waitcnt lgkmcnt(4)
    v_mfma_f32_16x16x32_bf16 v[4:7], v[212:215], v[172:175], v[4:7]
    v_mfma_f32_16x16x32_bf16 v[12:15], v[212:215], v[180:183], v[12:15]
    v_mfma_f32_16x16x32_bf16 v[20:23], v[212:215], v[188:191], v[20:23]
    s_waitcnt lgkmcnt(2)
    v_mfma_f32_16x16x32_bf16 v[24:27], v[216:219], v[172:175], v[24:27]
    v_mfma_f32_16x16x32_bf16 v[32:35], v[216:219], v[180:183], v[32:35]
    v_mfma_f32_16x16x32_bf16 v[40:43], v[216:219], v[188:191], v[40:43]
    s_waitcnt lgkmcnt(0)
    v_mfma_f32_16x16x32_bf16 v[28:31], v[220:223], v[172:175], v[28:31]
    v_mfma_f32_16x16x32_bf16 v[36:39], v[220:223], v[180:183], v[36:39]
    v_mfma_f32_16x16x32_bf16 v[44:47], v[220:223], v[188:191], v[44:47]
    v_add_u32 v228, s70, v227
    v_xor_b32 v229, 32, v228
    v_xor_b32 v230, 64, v228
    v_xor_b32 v231, 96, v228
    v_add_u32 v232, s71, v227
    v_xor_b32 v233, 32, v232
    v_xor_b32 v234, 64, v232
    v_xor_b32 v235, 96, v232
    s_barrier
    ds_read_b64_tr_b16 v[192:193], v228 offset:0
    ds_read_b64_tr_b16 v[194:195], v228 offset:2048
    ds_read_b64_tr_b16 v[196:197], v229 offset:0
    ds_read_b64_tr_b16 v[198:199], v229 offset:2048
    ds_read_b64_tr_b16 v[200:201], v230 offset:0
    ds_read_b64_tr_b16 v[202:203], v230 offset:2048
    ds_read_b64_tr_b16 v[204:205], v231 offset:0
    ds_read_b64_tr_b16 v[206:207], v231 offset:2048
    ds_read_b64_tr_b16 v[208:209], v228 offset:4096
    ds_read_b64_tr_b16 v[210:211], v228 offset:6144
    ds_read_b64_tr_b16 v[212:213], v229 offset:4096
    ds_read_b64_tr_b16 v[214:215], v229 offset:6144
    ds_read_b64_tr_b16 v[216:217], v230 offset:4096
    ds_read_b64_tr_b16 v[218:219], v230 offset:6144
    s_waitcnt lgkmcnt(12)
    v_mfma_f32_16x16x32_bf16 v[48:51], v[192:195], v[96:99], 0
    ds_read_b64_tr_b16 v[220:221], v231 offset:4096
    v_mfma_f32_16x16x32_bf16 v[56:59], v[192:195], v[104:107], 0
    ds_read_b64_tr_b16 v[222:223], v231 offset:6144
    v_mfma_f32_16x16x32_bf16 v[64:67], v[192:195], v[112:115], 0
    s_waitcnt lgkmcnt(12)
    v_mfma_f32_16x16x32_bf16 v[52:55], v[196:199], v[96:99], 0
    ds_read_b64_tr_b16 v[192:193], v228 offset:8192
    v_mfma_f32_16x16x32_bf16 v[60:63], v[196:199], v[104:107], 0
    ds_read_b64_tr_b16 v[194:195], v228 offset:10240
    v_mfma_f32_16x16x32_bf16 v[68:71], v[196:199], v[112:115], 0
    s_waitcnt lgkmcnt(12)
    v_mfma_f32_16x16x32_bf16 v[72:75], v[200:203], v[96:99], 0
    ds_read_b64_tr_b16 v[196:197], v229 offset:8192
    v_mfma_f32_16x16x32_bf16 v[80:83], v[200:203], v[104:107], 0
    ds_read_b64_tr_b16 v[198:199], v229 offset:10240
    v_mfma_f32_16x16x32_bf16 v[88:91], v[200:203], v[112:115], 0
    s_waitcnt lgkmcnt(12)
    v_mfma_f32_16x16x32_bf16 v[76:79], v[204:207], v[96:99], 0
    ds_read_b64_tr_b16 v[200:201], v230 offset:8192
    v_mfma_f32_16x16x32_bf16 v[84:87], v[204:207], v[104:107], 0
    ds_read_b64_tr_b16 v[202:203], v230 offset:10240
    v_mfma_f32_16x16x32_bf16 v[92:95], v[204:207], v[112:115], 0
    v_cvt_pk_bf16_f32 v0, v0, v1
    v_cvt_pk_bf16_f32 v1, v2, v3
    v_cvt_pk_bf16_f32 v2, v4, v5
    v_cvt_pk_bf16_f32 v3, v6, v7
    s_add_u32 s7, s84, 0
    buffer_store_dwordx4 v[0:3], v255, s[56:59], s7 offen sc1
    s_waitcnt lgkmcnt(12)
    v_mfma_f32_16x16x32_bf16 v[48:51], v[208:211], v[120:123], v[48:51]
    ds_read_b64_tr_b16 v[204:205], v231 offset:8192
    v_mfma_f32_16x16x32_bf16 v[56:59], v[208:211], v[128:131], v[56:59]
    ds_read_b64_tr_b16 v[206:207], v231 offset:10240
    v_mfma_f32_16x16x32_bf16 v[64:67], v[208:211], v[136:139], v[64:67]
    s_waitcnt lgkmcnt(12)
    v_mfma_f32_16x16x32_bf16 v[52:55], v[212:215], v[120:123], v[52:55]
    ds_read_b64_tr_b16 v[208:209], v228 offset:12288
    v_mfma_f32_16x16x32_bf16 v[60:63], v[212:215], v[128:131], v[60:63]
    ds_read_b64_tr_b16 v[210:211], v228 offset:14336
    v_mfma_f32_16x16x32_bf16 v[68:71], v[212:215], v[136:139], v[68:71]
    s_waitcnt lgkmcnt(12)
    v_mfma_f32_16x16x32_bf16 v[72:75], v[216:219], v[120:123], v[72:75]
    ds_read_b64_tr_b16 v[212:213], v229 offset:12288
    v_mfma_f32_16x16x32_bf16 v[80:83], v[216:219], v[128:131], v[80:83]
    ds_read_b64_tr_b16 v[214:215], v229 offset:14336
    v_mfma_f32_16x16x32_bf16 v[88:91], v[216:219], v[136:139], v[88:91]
    s_waitcnt lgkmcnt(12)
    v_mfma_f32_16x16x32_bf16 v[76:79], v[220:223], v[120:123], v[76:79]
    ds_read_b64_tr_b16 v[216:217], v230 offset:12288
    v_mfma_f32_16x16x32_bf16 v[84:87], v[220:223], v[128:131], v[84:87]
    ds_read_b64_tr_b16 v[218:219], v230 offset:14336
    v_mfma_f32_16x16x32_bf16 v[92:95], v[220:223], v[136:139], v[92:95]
    v_cvt_pk_bf16_f32 v8, v8, v9
    v_cvt_pk_bf16_f32 v9, v10, v11
    v_cvt_pk_bf16_f32 v10, v12, v13
    v_cvt_pk_bf16_f32 v11, v14, v15
    s_add_u32 s7, s84, 1024
    buffer_store_dwordx4 v[8:11], v255, s[56:59], s7 offen sc1
    s_waitcnt lgkmcnt(12)
    v_mfma_f32_16x16x32_bf16 v[48:51], v[192:195], v[144:147], v[48:51]
    ds_read_b64_tr_b16 v[220:221], v231 offset:12288
    v_mfma_f32_16x16x32_bf16 v[56:59], v[192:195], v[152:155], v[56:59]
    ds_read_b64_tr_b16 v[222:223], v231 offset:14336
    v_mfma_f32_16x16x32_bf16 v[64:67], v[192:195], v[160:163], v[64:67]
    s_waitcnt lgkmcnt(12)
    v_mfma_f32_16x16x32_bf16 v[52:55], v[196:199], v[144:147], v[52:55]
    ds_read_b64_tr_b16 v[192:193], v232 offset:0
    v_mfma_f32_16x16x32_bf16 v[60:63], v[196:199], v[152:155], v[60:63]
    ds_read_b64_tr_b16 v[194:195], v232 offset:2048
    v_mfma_f32_16x16x32_bf16 v[68:71], v[196:199], v[160:163], v[68:71]
    s_waitcnt lgkmcnt(12)
    v_mfma_f32_16x16x32_bf16 v[72:75], v[200:203], v[144:147], v[72:75]
    ds_read_b64_tr_b16 v[196:197], v233 offset:0
    v_mfma_f32_16x16x32_bf16 v[80:83], v[200:203], v[152:155], v[80:83]
    ds_read_b64_tr_b16 v[198:199], v233 offset:2048
    v_mfma_f32_16x16x32_bf16 v[88:91], v[200:203], v[160:163], v[88:91]
    s_waitcnt lgkmcnt(12)
    v_mfma_f32_16x16x32_bf16 v[76:79], v[204:207], v[144:147], v[76:79]
    ds_read_b64_tr_b16 v[200:201], v234 offset:0
    v_mfma_f32_16x16x32_bf16 v[84:87], v[204:207], v[152:155], v[84:87]
    ds_read_b64_tr_b16 v[202:203], v234 offset:2048
    v_mfma_f32_16x16x32_bf16 v[92:95], v[204:207], v[160:163], v[92:95]
    v_cvt_pk_bf16_f32 v16, v16, v17
    v_cvt_pk_bf16_f32 v17, v18, v19
    v_cvt_pk_bf16_f32 v18, v20, v21
    v_cvt_pk_bf16_f32 v19, v22, v23
    s_add_u32 s7, s84, 2048
    buffer_store_dwordx4 v[16:19], v255, s[56:59], s7 offen sc1
    s_waitcnt lgkmcnt(12)
    v_mfma_f32_16x16x32_bf16 v[48:51], v[208:211], v[168:171], v[48:51]
    ds_read_b64_tr_b16 v[204:205], v235 offset:0
    v_mfma_f32_16x16x32_bf16 v[56:59], v[208:211], v[176:179], v[56:59]
    ds_read_b64_tr_b16 v[206:207], v235 offset:2048
    v_mfma_f32_16x16x32_bf16 v[64:67], v[208:211], v[184:187], v[64:67]
    s_waitcnt lgkmcnt(12)
    v_mfma_f32_16x16x32_bf16 v[52:55], v[212:215], v[168:171], v[52:55]
    ds_read_b64_tr_b16 v[208:209], v232 offset:4096
    v_mfma_f32_16x16x32_bf16 v[60:63], v[212:215], v[176:179], v[60:63]
    ds_read_b64_tr_b16 v[210:211], v232 offset:6144
    v_mfma_f32_16x16x32_bf16 v[68:71], v[212:215], v[184:187], v[68:71]
    s_waitcnt lgkmcnt(12)
    v_mfma_f32_16x16x32_bf16 v[72:75], v[216:219], v[168:171], v[72:75]
    ds_read_b64_tr_b16 v[212:213], v233 offset:4096
    v_mfma_f32_16x16x32_bf16 v[80:83], v[216:219], v[176:179], v[80:83]
    ds_read_b64_tr_b16 v[214:215], v233 offset:6144
    v_mfma_f32_16x16x32_bf16 v[88:91], v[216:219], v[184:187], v[88:91]
    s_waitcnt lgkmcnt(12)
    v_mfma_f32_16x16x32_bf16 v[76:79], v[220:223], v[168:171], v[76:79]
    ds_read_b64_tr_b16 v[216:217], v234 offset:4096
    v_mfma_f32_16x16x32_bf16 v[84:87], v[220:223], v[176:179], v[84:87]
    ds_read_b64_tr_b16 v[218:219], v234 offset:6144
    v_mfma_f32_16x16x32_bf16 v[92:95], v[220:223], v[184:187], v[92:95]
    v_cvt_pk_bf16_f32 v24, v24, v25
    v_cvt_pk_bf16_f32 v25, v26, v27
    v_cvt_pk_bf16_f32 v26, v28, v29
    v_cvt_pk_bf16_f32 v27, v30, v31
    s_add_u32 s7, s84, 3072
    buffer_store_dwordx4 v[24:27], v255, s[56:59], s7 offen sc1
    s_waitcnt lgkmcnt(12)
    v_mfma_f32_16x16x32_bf16 v[48:51], v[192:195], v[100:103], v[48:51]
    ds_read_b64_tr_b16 v[220:221], v235 offset:4096
    v_mfma_f32_16x16x32_bf16 v[56:59], v[192:195], v[108:111], v[56:59]
    ds_read_b64_tr_b16 v[222:223], v235 offset:6144
    v_mfma_f32_16x16x32_bf16 v[64:67], v[192:195], v[116:119], v[64:67]
    s_waitcnt lgkmcnt(12)
    v_mfma_f32_16x16x32_bf16 v[52:55], v[196:199], v[100:103], v[52:55]
    ds_read_b64_tr_b16 v[192:193], v232 offset:8192
    v_mfma_f32_16x16x32_bf16 v[60:63], v[196:199], v[108:111], v[60:63]
    ds_read_b64_tr_b16 v[194:195], v232 offset:10240
    v_mfma_f32_16x16x32_bf16 v[68:71], v[196:199], v[116:119], v[68:71]
    s_waitcnt lgkmcnt(12)
    v_mfma_f32_16x16x32_bf16 v[72:75], v[200:203], v[100:103], v[72:75]
    ds_read_b64_tr_b16 v[196:197], v233 offset:8192
    v_mfma_f32_16x16x32_bf16 v[80:83], v[200:203], v[108:111], v[80:83]
    ds_read_b64_tr_b16 v[198:199], v233 offset:10240
    v_mfma_f32_16x16x32_bf16 v[88:91], v[200:203], v[116:119], v[88:91]
    s_waitcnt lgkmcnt(12)
    v_mfma_f32_16x16x32_bf16 v[76:79], v[204:207], v[100:103], v[76:79]
    ds_read_b64_tr_b16 v[200:201], v234 offset:8192
    v_mfma_f32_16x16x32_bf16 v[84:87], v[204:207], v[108:111], v[84:87]
    ds_read_b64_tr_b16 v[202:203], v234 offset:10240
    v_mfma_f32_16x16x32_bf16 v[92:95], v[204:207], v[116:119], v[92:95]
    v_cvt_pk_bf16_f32 v32, v32, v33
    v_cvt_pk_bf16_f32 v33, v34, v35
    v_cvt_pk_bf16_f32 v34, v36, v37
    v_cvt_pk_bf16_f32 v35, v38, v39
    s_add_u32 s7, s84, 4096
    buffer_store_dwordx4 v[32:35], v255, s[56:59], s7 offen sc1
    s_waitcnt lgkmcnt(12)
    v_mfma_f32_16x16x32_bf16 v[48:51], v[208:211], v[124:127], v[48:51]
    ds_read_b64_tr_b16 v[204:205], v235 offset:8192
    v_mfma_f32_16x16x32_bf16 v[56:59], v[208:211], v[132:135], v[56:59]
    ds_read_b64_tr_b16 v[206:207], v235 offset:10240
    v_mfma_f32_16x16x32_bf16 v[64:67], v[208:211], v[140:143], v[64:67]
    s_waitcnt lgkmcnt(12)
    v_mfma_f32_16x16x32_bf16 v[52:55], v[212:215], v[124:127], v[52:55]
    ds_read_b64_tr_b16 v[208:209], v232 offset:12288
    v_mfma_f32_16x16x32_bf16 v[60:63], v[212:215], v[132:135], v[60:63]
    ds_read_b64_tr_b16 v[210:211], v232 offset:14336
    v_mfma_f32_16x16x32_bf16 v[68:71], v[212:215], v[140:143], v[68:71]
    s_waitcnt lgkmcnt(12)
    v_mfma_f32_16x16x32_bf16 v[72:75], v[216:219], v[124:127], v[72:75]
    ds_read_b64_tr_b16 v[212:213], v233 offset:12288
    v_mfma_f32_16x16x32_bf16 v[80:83], v[216:219], v[132:135], v[80:83]
    ds_read_b64_tr_b16 v[214:215], v233 offset:14336
    v_mfma_f32_16x16x32_bf16 v[88:91], v[216:219], v[140:143], v[88:91]
    s_waitcnt lgkmcnt(12)
    v_mfma_f32_16x16x32_bf16 v[76:79], v[220:223], v[124:127], v[76:79]
    ds_read_b64_tr_b16 v[216:217], v234 offset:12288
    v_mfma_f32_16x16x32_bf16 v[84:87], v[220:223], v[132:135], v[84:87]
    ds_read_b64_tr_b16 v[218:219], v234 offset:14336
    v_mfma_f32_16x16x32_bf16 v[92:95], v[220:223], v[140:143], v[92:95]
    v_cvt_pk_bf16_f32 v40, v40, v41
    v_cvt_pk_bf16_f32 v41, v42, v43
    v_cvt_pk_bf16_f32 v42, v44, v45
    v_cvt_pk_bf16_f32 v43, v46, v47
    s_add_u32 s7, s84, 5120
    buffer_store_dwordx4 v[40:43], v255, s[56:59], s7 offen sc1
    s_waitcnt lgkmcnt(12)
    v_mfma_f32_16x16x32_bf16 v[48:51], v[192:195], v[148:151], v[48:51]
    ds_read_b64_tr_b16 v[220:221], v235 offset:12288
    v_mfma_f32_16x16x32_bf16 v[56:59], v[192:195], v[156:159], v[56:59]
    ds_read_b64_tr_b16 v[222:223], v235 offset:14336
    v_mfma_f32_16x16x32_bf16 v[64:67], v[192:195], v[164:167], v[64:67]
    s_waitcnt lgkmcnt(12)
    v_mfma_f32_16x16x32_bf16 v[52:55], v[196:199], v[148:151], v[52:55]
    v_mfma_f32_16x16x32_bf16 v[60:63], v[196:199], v[156:159], v[60:63]
    v_mfma_f32_16x16x32_bf16 v[68:71], v[196:199], v[164:167], v[68:71]
    s_waitcnt lgkmcnt(10)
    v_mfma_f32_16x16x32_bf16 v[72:75], v[200:203], v[148:151], v[72:75]
    v_mfma_f32_16x16x32_bf16 v[80:83], v[200:203], v[156:159], v[80:83]
    v_mfma_f32_16x16x32_bf16 v[88:91], v[200:203], v[164:167], v[88:91]
    s_waitcnt lgkmcnt(8)
    v_mfma_f32_16x16x32_bf16 v[76:79], v[204:207], v[148:151], v[76:79]
    v_mfma_f32_16x16x32_bf16 v[84:87], v[204:207], v[156:159], v[84:87]
    v_mfma_f32_16x16x32_bf16 v[92:95], v[204:207], v[164:167], v[92:95]
    s_waitcnt lgkmcnt(6)
    v_mfma_f32_16x16x32_bf16 v[48:51], v[208:211], v[172:175], v[48:51]
    v_mfma_f32_16x16x32_bf16 v[56:59], v[208:211], v[180:183], v[56:59]
    v_mfma_f32_16x16x32_bf16 v[64:67], v[208:211], v[188:191], v[64:67]
    s_waitcnt lgkmcnt(4)
    v_mfma_f32_16x16x32_bf16 v[52:55], v[212:215], v[172:175], v[52:55]
    v_mfma_f32_16x16x32_bf16 v[60:63], v[212:215], v[180:183], v[60:63]
    v_mfma_f32_16x16x32_bf16 v[68:71], v[212:215], v[188:191], v[68:71]
    s_waitcnt lgkmcnt(2)
    v_mfma_f32_16x16x32_bf16 v[72:75], v[216:219], v[172:175], v[72:75]
    v_mfma_f32_16x16x32_bf16 v[80:83], v[216:219], v[180:183], v[80:83]
    v_mfma_f32_16x16x32_bf16 v[88:91], v[216:219], v[188:191], v[88:91]
    s_waitcnt lgkmcnt(0)
    v_mfma_f32_16x16x32_bf16 v[76:79], v[220:223], v[172:175], v[76:79]
    v_mfma_f32_16x16x32_bf16 v[84:87], v[220:223], v[180:183], v[84:87]
    v_mfma_f32_16x16x32_bf16 v[92:95], v[220:223], v[188:191], v[92:95]
    v_add_u32 v228, s72, v227
    v_xor_b32 v229, 32, v228
    v_xor_b32 v230, 64, v228
    v_xor_b32 v231, 96, v228
    v_add_u32 v232, s73, v227
    v_xor_b32 v233, 32, v232
    v_xor_b32 v234, 64, v232
    v_xor_b32 v235, 96, v232
    s_barrier
    ds_read_b64_tr_b16 v[192:193], v228 offset:0
    ds_read_b64_tr_b16 v[194:195], v228 offset:2048
    ds_read_b64_tr_b16 v[196:197], v229 offset:0
    ds_read_b64_tr_b16 v[198:199], v229 offset:2048
    ds_read_b64_tr_b16 v[200:201], v230 offset:0
    ds_read_b64_tr_b16 v[202:203], v230 offset:2048
    ds_read_b64_tr_b16 v[204:205], v231 offset:0
    ds_read_b64_tr_b16 v[206:207], v231 offset:2048
    ds_read_b64_tr_b16 v[208:209], v228 offset:4096
    ds_read_b64_tr_b16 v[210:211], v228 offset:6144
    ds_read_b64_tr_b16 v[212:213], v229 offset:4096
    ds_read_b64_tr_b16 v[214:215], v229 offset:6144
    ds_read_b64_tr_b16 v[216:217], v230 offset:4096
    ds_read_b64_tr_b16 v[218:219], v230 offset:6144
    s_waitcnt lgkmcnt(12)
    v_mfma_f32_16x16x32_bf16 v[0:3], v[192:195], v[96:99], 0
    ds_read_b64_tr_b16 v[220:221], v231 offset:4096
    v_mfma_f32_16x16x32_bf16 v[8:11], v[192:195], v[104:107], 0
    ds_read_b64_tr_b16 v[222:223], v231 offset:6144
    v_mfma_f32_16x16x32_bf16 v[16:19], v[192:195], v[112:115], 0
    s_waitcnt lgkmcnt(12)
    v_mfma_f32_16x16x32_bf16 v[4:7], v[196:199], v[96:99], 0
    ds_read_b64_tr_b16 v[192:193], v228 offset:8192
    v_mfma_f32_16x16x32_bf16 v[12:15], v[196:199], v[104:107], 0
    ds_read_b64_tr_b16 v[194:195], v228 offset:10240
    v_mfma_f32_16x16x32_bf16 v[20:23], v[196:199], v[112:115], 0
    s_waitcnt lgkmcnt(12)
    v_mfma_f32_16x16x32_bf16 v[24:27], v[200:203], v[96:99], 0
    ds_read_b64_tr_b16 v[196:197], v229 offset:8192
    v_mfma_f32_16x16x32_bf16 v[32:35], v[200:203], v[104:107], 0
    ds_read_b64_tr_b16 v[198:199], v229 offset:10240
    v_mfma_f32_16x16x32_bf16 v[40:43], v[200:203], v[112:115], 0
    s_waitcnt lgkmcnt(12)
    v_mfma_f32_16x16x32_bf16 v[28:31], v[204:207], v[96:99], 0
    ds_read_b64_tr_b16 v[200:201], v230 offset:8192
    v_mfma_f32_16x16x32_bf16 v[36:39], v[204:207], v[104:107], 0
    ds_read_b64_tr_b16 v[202:203], v230 offset:10240
    v_mfma_f32_16x16x32_bf16 v[44:47], v[204:207], v[112:115], 0
    v_cvt_pk_bf16_f32 v48, v48, v49
    v_cvt_pk_bf16_f32 v49, v50, v51
    v_cvt_pk_bf16_f32 v50, v52, v53
    v_cvt_pk_bf16_f32 v51, v54, v55
    s_add_u32 s7, s85, 0
    buffer_store_dwordx4 v[48:51], v255, s[56:59], s7 offen sc1
    s_waitcnt lgkmcnt(12)
    v_mfma_f32_16x16x32_bf16 v[0:3], v[208:211], v[120:123], v[0:3]
    ds_read_b64_tr_b16 v[204:205], v231 offset:8192
    v_mfma_f32_16x16x32_bf16 v[8:11], v[208:211], v[128:131], v[8:11]
    ds_read_b64_tr_b16 v[206:207], v231 offset:10240
    v_mfma_f32_16x16x32_bf16 v[16:19], v[208:211], v[136:139], v[16:19]
    s_waitcnt lgkmcnt(12)
    v_mfma_f32_16x16x32_bf16 v[4:7], v[212:215], v[120:123], v[4:7]
    ds_read_b64_tr_b16 v[208:209], v228 offset:12288
    v_mfma_f32_16x16x32_bf16 v[12:15], v[212:215], v[128:131], v[12:15]
    ds_read_b64_tr_b16 v[210:211], v228 offset:14336
    v_mfma_f32_16x16x32_bf16 v[20:23], v[212:215], v[136:139], v[20:23]
    s_waitcnt lgkmcnt(12)
    v_mfma_f32_16x16x32_bf16 v[24:27], v[216:219], v[120:123], v[24:27]
    ds_read_b64_tr_b16 v[212:213], v229 offset:12288
    v_mfma_f32_16x16x32_bf16 v[32:35], v[216:219], v[128:131], v[32:35]
    ds_read_b64_tr_b16 v[214:215], v229 offset:14336
    v_mfma_f32_16x16x32_bf16 v[40:43], v[216:219], v[136:139], v[40:43]
    s_waitcnt lgkmcnt(12)
    v_mfma_f32_16x16x32_bf16 v[28:31], v[220:223], v[120:123], v[28:31]
    ds_read_b64_tr_b16 v[216:217], v230 offset:12288
    v_mfma_f32_16x16x32_bf16 v[36:39], v[220:223], v[128:131], v[36:39]
    ds_read_b64_tr_b16 v[218:219], v230 offset:14336
    v_mfma_f32_16x16x32_bf16 v[44:47], v[220:223], v[136:139], v[44:47]
    v_cvt_pk_bf16_f32 v56, v56, v57
    v_cvt_pk_bf16_f32 v57, v58, v59
    v_cvt_pk_bf16_f32 v58, v60, v61
    v_cvt_pk_bf16_f32 v59, v62, v63
    s_add_u32 s7, s85, 1024
    buffer_store_dwordx4 v[56:59], v255, s[56:59], s7 offen sc1
    s_waitcnt lgkmcnt(12)
    v_mfma_f32_16x16x32_bf16 v[0:3], v[192:195], v[144:147], v[0:3]
    ds_read_b64_tr_b16 v[220:221], v231 offset:12288
    v_mfma_f32_16x16x32_bf16 v[8:11], v[192:195], v[152:155], v[8:11]
    ds_read_b64_tr_b16 v[222:223], v231 offset:14336
    v_mfma_f32_16x16x32_bf16 v[16:19], v[192:195], v[160:163], v[16:19]
    s_waitcnt lgkmcnt(12)
    v_mfma_f32_16x16x32_bf16 v[4:7], v[196:199], v[144:147], v[4:7]
    ds_read_b64_tr_b16 v[192:193], v232 offset:0
    v_mfma_f32_16x16x32_bf16 v[12:15], v[196:199], v[152:155], v[12:15]
    ds_read_b64_tr_b16 v[194:195], v232 offset:2048
    v_mfma_f32_16x16x32_bf16 v[20:23], v[196:199], v[160:163], v[20:23]
    s_waitcnt lgkmcnt(12)
    v_mfma_f32_16x16x32_bf16 v[24:27], v[200:203], v[144:147], v[24:27]
    ds_read_b64_tr_b16 v[196:197], v233 offset:0
    v_mfma_f32_16x16x32_bf16 v[32:35], v[200:203], v[152:155], v[32:35]
    ds_read_b64_tr_b16 v[198:199], v233 offset:2048
    v_mfma_f32_16x16x32_bf16 v[40:43], v[200:203], v[160:163], v[40:43]
    s_waitcnt lgkmcnt(12)
    v_mfma_f32_16x16x32_bf16 v[28:31], v[204:207], v[144:147], v[28:31]
    ds_read_b64_tr_b16 v[200:201], v234 offset:0
    v_mfma_f32_16x16x32_bf16 v[36:39], v[204:207], v[152:155], v[36:39]
    ds_read_b64_tr_b16 v[202:203], v234 offset:2048
    v_mfma_f32_16x16x32_bf16 v[44:47], v[204:207], v[160:163], v[44:47]
    v_cvt_pk_bf16_f32 v64, v64, v65
    v_cvt_pk_bf16_f32 v65, v66, v67
    v_cvt_pk_bf16_f32 v66, v68, v69
    v_cvt_pk_bf16_f32 v67, v70, v71
    s_add_u32 s7, s85, 2048
    buffer_store_dwordx4 v[64:67], v255, s[56:59], s7 offen sc1
    s_waitcnt lgkmcnt(12)
    v_mfma_f32_16x16x32_bf16 v[0:3], v[208:211], v[168:171], v[0:3]
    ds_read_b64_tr_b16 v[204:205], v235 offset:0
    v_mfma_f32_16x16x32_bf16 v[8:11], v[208:211], v[176:179], v[8:11]
    ds_read_b64_tr_b16 v[206:207], v235 offset:2048
    v_mfma_f32_16x16x32_bf16 v[16:19], v[208:211], v[184:187], v[16:19]
    s_waitcnt lgkmcnt(12)
    v_mfma_f32_16x16x32_bf16 v[4:7], v[212:215], v[168:171], v[4:7]
    ds_read_b64_tr_b16 v[208:209], v232 offset:4096
    v_mfma_f32_16x16x32_bf16 v[12:15], v[212:215], v[176:179], v[12:15]
    ds_read_b64_tr_b16 v[210:211], v232 offset:6144
    v_mfma_f32_16x16x32_bf16 v[20:23], v[212:215], v[184:187], v[20:23]
    s_waitcnt lgkmcnt(12)
    v_mfma_f32_16x16x32_bf16 v[24:27], v[216:219], v[168:171], v[24:27]
    ds_read_b64_tr_b16 v[212:213], v233 offset:4096
    v_mfma_f32_16x16x32_bf16 v[32:35], v[216:219], v[176:179], v[32:35]
    ds_read_b64_tr_b16 v[214:215], v233 offset:6144
    v_mfma_f32_16x16x32_bf16 v[40:43], v[216:219], v[184:187], v[40:43]
    s_waitcnt lgkmcnt(12)
    v_mfma_f32_16x16x32_bf16 v[28:31], v[220:223], v[168:171], v[28:31]
    ds_read_b64_tr_b16 v[216:217], v234 offset:4096
    v_mfma_f32_16x16x32_bf16 v[36:39], v[220:223], v[176:179], v[36:39]
    ds_read_b64_tr_b16 v[218:219], v234 offset:6144
    v_mfma_f32_16x16x32_bf16 v[44:47], v[220:223], v[184:187], v[44:47]
    v_cvt_pk_bf16_f32 v72, v72, v73
    v_cvt_pk_bf16_f32 v73, v74, v75
    v_cvt_pk_bf16_f32 v74, v76, v77
    v_cvt_pk_bf16_f32 v75, v78, v79
    s_add_u32 s7, s85, 3072
    buffer_store_dwordx4 v[72:75], v255, s[56:59], s7 offen sc1
    s_waitcnt lgkmcnt(12)
    v_mfma_f32_16x16x32_bf16 v[0:3], v[192:195], v[100:103], v[0:3]
    ds_read_b64_tr_b16 v[220:221], v235 offset:4096
    v_mfma_f32_16x16x32_bf16 v[8:11], v[192:195], v[108:111], v[8:11]
    ds_read_b64_tr_b16 v[222:223], v235 offset:6144
    v_mfma_f32_16x16x32_bf16 v[16:19], v[192:195], v[116:119], v[16:19]
    s_waitcnt lgkmcnt(12)
    v_mfma_f32_16x16x32_bf16 v[4:7], v[196:199], v[100:103], v[4:7]
    ds_read_b64_tr_b16 v[192:193], v232 offset:8192
    v_mfma_f32_16x16x32_bf16 v[12:15], v[196:199], v[108:111], v[12:15]
    ds_read_b64_tr_b16 v[194:195], v232 offset:10240
    v_mfma_f32_16x16x32_bf16 v[20:23], v[196:199], v[116:119], v[20:23]
    s_waitcnt lgkmcnt(12)
    v_mfma_f32_16x16x32_bf16 v[24:27], v[200:203], v[100:103], v[24:27]
    ds_read_b64_tr_b16 v[196:197], v233 offset:8192
    v_mfma_f32_16x16x32_bf16 v[32:35], v[200:203], v[108:111], v[32:35]
    ds_read_b64_tr_b16 v[198:199], v233 offset:10240
    v_mfma_f32_16x16x32_bf16 v[40:43], v[200:203], v[116:119], v[40:43]
    s_waitcnt lgkmcnt(12)
    v_mfma_f32_16x16x32_bf16 v[28:31], v[204:207], v[100:103], v[28:31]
    ds_read_b64_tr_b16 v[200:201], v234 offset:8192
    v_mfma_f32_16x16x32_bf16 v[36:39], v[204:207], v[108:111], v[36:39]
    ds_read_b64_tr_b16 v[202:203], v234 offset:10240
    v_mfma_f32_16x16x32_bf16 v[44:47], v[204:207], v[116:119], v[44:47]
    v_cvt_pk_bf16_f32 v80, v80, v81
    v_cvt_pk_bf16_f32 v81, v82, v83
    v_cvt_pk_bf16_f32 v82, v84, v85
    v_cvt_pk_bf16_f32 v83, v86, v87
    s_add_u32 s7, s85, 4096
    buffer_store_dwordx4 v[80:83], v255, s[56:59], s7 offen sc1
    s_waitcnt lgkmcnt(12)
    v_mfma_f32_16x16x32_bf16 v[0:3], v[208:211], v[124:127], v[0:3]
    ds_read_b64_tr_b16 v[204:205], v235 offset:8192
    v_mfma_f32_16x16x32_bf16 v[8:11], v[208:211], v[132:135], v[8:11]
    ds_read_b64_tr_b16 v[206:207], v235 offset:10240
    v_mfma_f32_16x16x32_bf16 v[16:19], v[208:211], v[140:143], v[16:19]
    s_waitcnt lgkmcnt(12)
    v_mfma_f32_16x16x32_bf16 v[4:7], v[212:215], v[124:127], v[4:7]
    ds_read_b64_tr_b16 v[208:209], v232 offset:12288
    v_mfma_f32_16x16x32_bf16 v[12:15], v[212:215], v[132:135], v[12:15]
    ds_read_b64_tr_b16 v[210:211], v232 offset:14336
    v_mfma_f32_16x16x32_bf16 v[20:23], v[212:215], v[140:143], v[20:23]
    s_waitcnt lgkmcnt(12)
    v_mfma_f32_16x16x32_bf16 v[24:27], v[216:219], v[124:127], v[24:27]
    ds_read_b64_tr_b16 v[212:213], v233 offset:12288
    v_mfma_f32_16x16x32_bf16 v[32:35], v[216:219], v[132:135], v[32:35]
    ds_read_b64_tr_b16 v[214:215], v233 offset:14336
    v_mfma_f32_16x16x32_bf16 v[40:43], v[216:219], v[140:143], v[40:43]
    s_waitcnt lgkmcnt(12)
    v_mfma_f32_16x16x32_bf16 v[28:31], v[220:223], v[124:127], v[28:31]
    ds_read_b64_tr_b16 v[216:217], v234 offset:12288
    v_mfma_f32_16x16x32_bf16 v[36:39], v[220:223], v[132:135], v[36:39]
    ds_read_b64_tr_b16 v[218:219], v234 offset:14336
    v_mfma_f32_16x16x32_bf16 v[44:47], v[220:223], v[140:143], v[44:47]
    v_cvt_pk_bf16_f32 v88, v88, v89
    v_cvt_pk_bf16_f32 v89, v90, v91
    v_cvt_pk_bf16_f32 v90, v92, v93
    v_cvt_pk_bf16_f32 v91, v94, v95
    s_add_u32 s7, s85, 5120
    buffer_store_dwordx4 v[88:91], v255, s[56:59], s7 offen sc1
    s_waitcnt lgkmcnt(12)
    v_mfma_f32_16x16x32_bf16 v[0:3], v[192:195], v[148:151], v[0:3]
    ds_read_b64_tr_b16 v[220:221], v235 offset:12288
    v_mfma_f32_16x16x32_bf16 v[8:11], v[192:195], v[156:159], v[8:11]
    ds_read_b64_tr_b16 v[222:223], v235 offset:14336
    v_mfma_f32_16x16x32_bf16 v[16:19], v[192:195], v[164:167], v[16:19]
    s_waitcnt lgkmcnt(12)
    v_mfma_f32_16x16x32_bf16 v[4:7], v[196:199], v[148:151], v[4:7]
    v_mfma_f32_16x16x32_bf16 v[12:15], v[196:199], v[156:159], v[12:15]
    v_mfma_f32_16x16x32_bf16 v[20:23], v[196:199], v[164:167], v[20:23]
    s_waitcnt lgkmcnt(10)
    v_mfma_f32_16x16x32_bf16 v[24:27], v[200:203], v[148:151], v[24:27]
    v_mfma_f32_16x16x32_bf16 v[32:35], v[200:203], v[156:159], v[32:35]
    v_mfma_f32_16x16x32_bf16 v[40:43], v[200:203], v[164:167], v[40:43]
    s_waitcnt lgkmcnt(8)
    v_mfma_f32_16x16x32_bf16 v[28:31], v[204:207], v[148:151], v[28:31]
    v_mfma_f32_16x16x32_bf16 v[36:39], v[204:207], v[156:159], v[36:39]
    v_mfma_f32_16x16x32_bf16 v[44:47], v[204:207], v[164:167], v[44:47]
    s_waitcnt lgkmcnt(6)
    v_mfma_f32_16x16x32_bf16 v[0:3], v[208:211], v[172:175], v[0:3]
    v_mfma_f32_16x16x32_bf16 v[8:11], v[208:211], v[180:183], v[8:11]
    v_mfma_f32_16x16x32_bf16 v[16:19], v[208:211], v[188:191], v[16:19]
    s_waitcnt lgkmcnt(4)
    v_mfma_f32_16x16x32_bf16 v[4:7], v[212:215], v[172:175], v[4:7]
    v_mfma_f32_16x16x32_bf16 v[12:15], v[212:215], v[180:183], v[12:15]
    v_mfma_f32_16x16x32_bf16 v[20:23], v[212:215], v[188:191], v[20:23]
    s_waitcnt lgkmcnt(2)
    v_mfma_f32_16x16x32_bf16 v[24:27], v[216:219], v[172:175], v[24:27]
    v_mfma_f32_16x16x32_bf16 v[32:35], v[216:219], v[180:183], v[32:35]
    v_mfma_f32_16x16x32_bf16 v[40:43], v[216:219], v[188:191], v[40:43]
    s_waitcnt lgkmcnt(0)
    v_mfma_f32_16x16x32_bf16 v[28:31], v[220:223], v[172:175], v[28:31]
    v_mfma_f32_16x16x32_bf16 v[36:39], v[220:223], v[180:183], v[36:39]
    v_mfma_f32_16x16x32_bf16 v[44:47], v[220:223], v[188:191], v[44:47]
    v_add_u32 v228, s74, v227
    v_xor_b32 v229, 32, v228
    v_xor_b32 v230, 64, v228
    v_xor_b32 v231, 96, v228
    v_add_u32 v232, s75, v227
    v_xor_b32 v233, 32, v232
    v_xor_b32 v234, 64, v232
    v_xor_b32 v235, 96, v232
    s_barrier
    ds_read_b64_tr_b16 v[192:193], v228 offset:0
    ds_read_b64_tr_b16 v[194:195], v228 offset:2048
    ds_read_b64_tr_b16 v[196:197], v229 offset:0
    ds_read_b64_tr_b16 v[198:199], v229 offset:2048
    ds_read_b64_tr_b16 v[200:201], v230 offset:0
    ds_read_b64_tr_b16 v[202:203], v230 offset:2048
    ds_read_b64_tr_b16 v[204:205], v231 offset:0
    ds_read_b64_tr_b16 v[206:207], v231 offset:2048
    ds_read_b64_tr_b16 v[208:209], v228 offset:4096
    ds_read_b64_tr_b16 v[210:211], v228 offset:6144
    ds_read_b64_tr_b16 v[212:213], v229 offset:4096
    ds_read_b64_tr_b16 v[214:215], v229 offset:6144
    ds_read_b64_tr_b16 v[216:217], v230 offset:4096
    ds_read_b64_tr_b16 v[218:219], v230 offset:6144
    s_waitcnt lgkmcnt(12)
    v_mfma_f32_16x16x32_bf16 v[48:51], v[192:195], v[96:99], 0
    ds_read_b64_tr_b16 v[220:221], v231 offset:4096
    v_mfma_f32_16x16x32_bf16 v[56:59], v[192:195], v[104:107], 0
    ds_read_b64_tr_b16 v[222:223], v231 offset:6144
    v_mfma_f32_16x16x32_bf16 v[64:67], v[192:195], v[112:115], 0
    s_waitcnt lgkmcnt(12)
    v_mfma_f32_16x16x32_bf16 v[52:55], v[196:199], v[96:99], 0
    ds_read_b64_tr_b16 v[192:193], v228 offset:8192
    v_mfma_f32_16x16x32_bf16 v[60:63], v[196:199], v[104:107], 0
    ds_read_b64_tr_b16 v[194:195], v228 offset:10240
    v_mfma_f32_16x16x32_bf16 v[68:71], v[196:199], v[112:115], 0
    s_waitcnt lgkmcnt(12)
    v_mfma_f32_16x16x32_bf16 v[72:75], v[200:203], v[96:99], 0
    ds_read_b64_tr_b16 v[196:197], v229 offset:8192
    v_mfma_f32_16x16x32_bf16 v[80:83], v[200:203], v[104:107], 0
    ds_read_b64_tr_b16 v[198:199], v229 offset:10240
    v_mfma_f32_16x16x32_bf16 v[88:91], v[200:203], v[112:115], 0
    s_waitcnt lgkmcnt(12)
    v_mfma_f32_16x16x32_bf16 v[76:79], v[204:207], v[96:99], 0
    ds_read_b64_tr_b16 v[200:201], v230 offset:8192
    v_mfma_f32_16x16x32_bf16 v[84:87], v[204:207], v[104:107], 0
    ds_read_b64_tr_b16 v[202:203], v230 offset:10240
    v_mfma_f32_16x16x32_bf16 v[92:95], v[204:207], v[112:115], 0
    v_cvt_pk_bf16_f32 v0, v0, v1
    v_cvt_pk_bf16_f32 v1, v2, v3
    v_cvt_pk_bf16_f32 v2, v4, v5
    v_cvt_pk_bf16_f32 v3, v6, v7
    s_add_u32 s7, s86, 0
    buffer_store_dwordx4 v[0:3], v255, s[56:59], s7 offen sc1
    s_waitcnt lgkmcnt(12)
    v_mfma_f32_16x16x32_bf16 v[48:51], v[208:211], v[120:123], v[48:51]
    ds_read_b64_tr_b16 v[204:205], v231 offset:8192
    v_mfma_f32_16x16x32_bf16 v[56:59], v[208:211], v[128:131], v[56:59]
    ds_read_b64_tr_b16 v[206:207], v231 offset:10240
    v_mfma_f32_16x16x32_bf16 v[64:67], v[208:211], v[136:139], v[64:67]
    s_waitcnt lgkmcnt(12)
    v_mfma_f32_16x16x32_bf16 v[52:55], v[212:215], v[120:123], v[52:55]
    ds_read_b64_tr_b16 v[208:209], v228 offset:12288
    v_mfma_f32_16x16x32_bf16 v[60:63], v[212:215], v[128:131], v[60:63]
    ds_read_b64_tr_b16 v[210:211], v228 offset:14336
    v_mfma_f32_16x16x32_bf16 v[68:71], v[212:215], v[136:139], v[68:71]
    s_waitcnt lgkmcnt(12)
    v_mfma_f32_16x16x32_bf16 v[72:75], v[216:219], v[120:123], v[72:75]
    ds_read_b64_tr_b16 v[212:213], v229 offset:12288
    v_mfma_f32_16x16x32_bf16 v[80:83], v[216:219], v[128:131], v[80:83]
    ds_read_b64_tr_b16 v[214:215], v229 offset:14336
    v_mfma_f32_16x16x32_bf16 v[88:91], v[216:219], v[136:139], v[88:91]
    s_waitcnt lgkmcnt(12)
    v_mfma_f32_16x16x32_bf16 v[76:79], v[220:223], v[120:123], v[76:79]
    ds_read_b64_tr_b16 v[216:217], v230 offset:12288
    v_mfma_f32_16x16x32_bf16 v[84:87], v[220:223], v[128:131], v[84:87]
    ds_read_b64_tr_b16 v[218:219], v230 offset:14336
    v_mfma_f32_16x16x32_bf16 v[92:95], v[220:223], v[136:139], v[92:95]
    v_cvt_pk_bf16_f32 v8, v8, v9
    v_cvt_pk_bf16_f32 v9, v10, v11
    v_cvt_pk_bf16_f32 v10, v12, v13
    v_cvt_pk_bf16_f32 v11, v14, v15
    s_add_u32 s7, s86, 1024
    buffer_store_dwordx4 v[8:11], v255, s[56:59], s7 offen sc1
    s_waitcnt lgkmcnt(12)
    v_mfma_f32_16x16x32_bf16 v[48:51], v[192:195], v[144:147], v[48:51]
    ds_read_b64_tr_b16 v[220:221], v231 offset:12288
    v_mfma_f32_16x16x32_bf16 v[56:59], v[192:195], v[152:155], v[56:59]
    ds_read_b64_tr_b16 v[222:223], v231 offset:14336
    v_mfma_f32_16x16x32_bf16 v[64:67], v[192:195], v[160:163], v[64:67]
    s_waitcnt lgkmcnt(12)
    v_mfma_f32_16x16x32_bf16 v[52:55], v[196:199], v[144:147], v[52:55]
    ds_read_b64_tr_b16 v[192:193], v232 offset:0
    v_mfma_f32_16x16x32_bf16 v[60:63], v[196:199], v[152:155], v[60:63]
    ds_read_b64_tr_b16 v[194:195], v232 offset:2048
    v_mfma_f32_16x16x32_bf16 v[68:71], v[196:199], v[160:163], v[68:71]
    s_waitcnt lgkmcnt(12)
    v_mfma_f32_16x16x32_bf16 v[72:75], v[200:203], v[144:147], v[72:75]
    ds_read_b64_tr_b16 v[196:197], v233 offset:0
    v_mfma_f32_16x16x32_bf16 v[80:83], v[200:203], v[152:155], v[80:83]
    ds_read_b64_tr_b16 v[198:199], v233 offset:2048
    v_mfma_f32_16x16x32_bf16 v[88:91], v[200:203], v[160:163], v[88:91]
    s_waitcnt lgkmcnt(12)
    v_mfma_f32_16x16x32_bf16 v[76:79], v[204:207], v[144:147], v[76:79]
    ds_read_b64_tr_b16 v[200:201], v234 offset:0
    v_mfma_f32_16x16x32_bf16 v[84:87], v[204:207], v[152:155], v[84:87]
    ds_read_b64_tr_b16 v[202:203], v234 offset:2048
    v_mfma_f32_16x16x32_bf16 v[92:95], v[204:207], v[160:163], v[92:95]
    v_cvt_pk_bf16_f32 v16, v16, v17
    v_cvt_pk_bf16_f32 v17, v18, v19
    v_cvt_pk_bf16_f32 v18, v20, v21
    v_cvt_pk_bf16_f32 v19, v22, v23
    s_add_u32 s7, s86, 2048
    buffer_store_dwordx4 v[16:19], v255, s[56:59], s7 offen sc1
    s_waitcnt lgkmcnt(12)
    v_mfma_f32_16x16x32_bf16 v[48:51], v[208:211], v[168:171], v[48:51]
    ds_read_b64_tr_b16 v[204:205], v235 offset:0
    v_mfma_f32_16x16x32_bf16 v[56:59], v[208:211], v[176:179], v[56:59]
    ds_read_b64_tr_b16 v[206:207], v235 offset:2048
    v_mfma_f32_16x16x32_bf16 v[64:67], v[208:211], v[184:187], v[64:67]
    s_waitcnt lgkmcnt(12)
    v_mfma_f32_16x16x32_bf16 v[52:55], v[212:215], v[168:171], v[52:55]
    ds_read_b64_tr_b16 v[208:209], v232 offset:4096
    v_mfma_f32_16x16x32_bf16 v[60:63], v[212:215], v[176:179], v[60:63]
    ds_read_b64_tr_b16 v[210:211], v232 offset:6144
    v_mfma_f32_16x16x32_bf16 v[68:71], v[212:215], v[184:187], v[68:71]
    s_waitcnt lgkmcnt(12)
    v_mfma_f32_16x16x32_bf16 v[72:75], v[216:219], v[168:171], v[72:75]
    ds_read_b64_tr_b16 v[212:213], v233 offset:4096
    v_mfma_f32_16x16x32_bf16 v[80:83], v[216:219], v[176:179], v[80:83]
    ds_read_b64_tr_b16 v[214:215], v233 offset:6144
    v_mfma_f32_16x16x32_bf16 v[88:91], v[216:219], v[184:187], v[88:91]
    s_waitcnt lgkmcnt(12)
    v_mfma_f32_16x16x32_bf16 v[76:79], v[220:223], v[168:171], v[76:79]
    ds_read_b64_tr_b16 v[216:217], v234 offset:4096
    v_mfma_f32_16x16x32_bf16 v[84:87], v[220:223], v[176:179], v[84:87]
    ds_read_b64_tr_b16 v[218:219], v234 offset:6144
    v_mfma_f32_16x16x32_bf16 v[92:95], v[220:223], v[184:187], v[92:95]
    v_cvt_pk_bf16_f32 v24, v24, v25
    v_cvt_pk_bf16_f32 v25, v26, v27
    v_cvt_pk_bf16_f32 v26, v28, v29
    v_cvt_pk_bf16_f32 v27, v30, v31
    s_add_u32 s7, s86, 3072
    buffer_store_dwordx4 v[24:27], v255, s[56:59], s7 offen sc1
    s_waitcnt lgkmcnt(12)
    v_mfma_f32_16x16x32_bf16 v[48:51], v[192:195], v[100:103], v[48:51]
    ds_read_b64_tr_b16 v[220:221], v235 offset:4096
    v_mfma_f32_16x16x32_bf16 v[56:59], v[192:195], v[108:111], v[56:59]
    ds_read_b64_tr_b16 v[222:223], v235 offset:6144
    v_mfma_f32_16x16x32_bf16 v[64:67], v[192:195], v[116:119], v[64:67]
    s_waitcnt lgkmcnt(12)
    v_mfma_f32_16x16x32_bf16 v[52:55], v[196:199], v[100:103], v[52:55]
    ds_read_b64_tr_b16 v[192:193], v232 offset:8192
    v_mfma_f32_16x16x32_bf16 v[60:63], v[196:199], v[108:111], v[60:63]
    ds_read_b64_tr_b16 v[194:195], v232 offset:10240
    v_mfma_f32_16x16x32_bf16 v[68:71], v[196:199], v[116:119], v[68:71]
    s_waitcnt lgkmcnt(12)
    v_mfma_f32_16x16x32_bf16 v[72:75], v[200:203], v[100:103], v[72:75]
    ds_read_b64_tr_b16 v[196:197], v233 offset:8192
    v_mfma_f32_16x16x32_bf16 v[80:83], v[200:203], v[108:111], v[80:83]
    ds_read_b64_tr_b16 v[198:199], v233 offset:10240
    v_mfma_f32_16x16x32_bf16 v[88:91], v[200:203], v[116:119], v[88:91]
    s_waitcnt lgkmcnt(12)
    v_mfma_f32_16x16x32_bf16 v[76:79], v[204:207], v[100:103], v[76:79]
    ds_read_b64_tr_b16 v[200:201], v234 offset:8192
    v_mfma_f32_16x16x32_bf16 v[84:87], v[204:207], v[108:111], v[84:87]
    ds_read_b64_tr_b16 v[202:203], v234 offset:10240
    v_mfma_f32_16x16x32_bf16 v[92:95], v[204:207], v[116:119], v[92:95]
    v_cvt_pk_bf16_f32 v32, v32, v33
    v_cvt_pk_bf16_f32 v33, v34, v35
    v_cvt_pk_bf16_f32 v34, v36, v37
    v_cvt_pk_bf16_f32 v35, v38, v39
    s_add_u32 s7, s86, 4096
    buffer_store_dwordx4 v[32:35], v255, s[56:59], s7 offen sc1
    s_waitcnt lgkmcnt(12)
    v_mfma_f32_16x16x32_bf16 v[48:51], v[208:211], v[124:127], v[48:51]
    ds_read_b64_tr_b16 v[204:205], v235 offset:8192
    v_mfma_f32_16x16x32_bf16 v[56:59], v[208:211], v[132:135], v[56:59]
    ds_read_b64_tr_b16 v[206:207], v235 offset:10240
    v_mfma_f32_16x16x32_bf16 v[64:67], v[208:211], v[140:143], v[64:67]
    s_waitcnt lgkmcnt(12)
    v_mfma_f32_16x16x32_bf16 v[52:55], v[212:215], v[124:127], v[52:55]
    ds_read_b64_tr_b16 v[208:209], v232 offset:12288
    v_mfma_f32_16x16x32_bf16 v[60:63], v[212:215], v[132:135], v[60:63]
    ds_read_b64_tr_b16 v[210:211], v232 offset:14336
    v_mfma_f32_16x16x32_bf16 v[68:71], v[212:215], v[140:143], v[68:71]
    s_waitcnt lgkmcnt(12)
    v_mfma_f32_16x16x32_bf16 v[72:75], v[216:219], v[124:127], v[72:75]
    ds_read_b64_tr_b16 v[212:213], v233 offset:12288
    v_mfma_f32_16x16x32_bf16 v[80:83], v[216:219], v[132:135], v[80:83]
    ds_read_b64_tr_b16 v[214:215], v233 offset:14336
    v_mfma_f32_16x16x32_bf16 v[88:91], v[216:219], v[140:143], v[88:91]
    s_waitcnt lgkmcnt(12)
    v_mfma_f32_16x16x32_bf16 v[76:79], v[220:223], v[124:127], v[76:79]
    ds_read_b64_tr_b16 v[216:217], v234 offset:12288
    v_mfma_f32_16x16x32_bf16 v[84:87], v[220:223], v[132:135], v[84:87]
    ds_read_b64_tr_b16 v[218:219], v234 offset:14336
    v_mfma_f32_16x16x32_bf16 v[92:95], v[220:223], v[140:143], v[92:95]
    v_cvt_pk_bf16_f32 v40, v40, v41
    v_cvt_pk_bf16_f32 v41, v42, v43
    v_cvt_pk_bf16_f32 v42, v44, v45
    v_cvt_pk_bf16_f32 v43, v46, v47
    s_add_u32 s7, s86, 5120
    buffer_store_dwordx4 v[40:43], v255, s[56:59], s7 offen sc1
    s_waitcnt lgkmcnt(12)
    v_mfma_f32_16x16x32_bf16 v[48:51], v[192:195], v[148:151], v[48:51]
    ds_read_b64_tr_b16 v[220:221], v235 offset:12288
    v_mfma_f32_16x16x32_bf16 v[56:59], v[192:195], v[156:159], v[56:59]
    ds_read_b64_tr_b16 v[222:223], v235 offset:14336
    v_mfma_f32_16x16x32_bf16 v[64:67], v[192:195], v[164:167], v[64:67]
    s_waitcnt lgkmcnt(12)
    v_mfma_f32_16x16x32_bf16 v[52:55], v[196:199], v[148:151], v[52:55]
    v_mfma_f32_16x16x32_bf16 v[60:63], v[196:199], v[156:159], v[60:63]
    v_mfma_f32_16x16x32_bf16 v[68:71], v[196:199], v[164:167], v[68:71]
    s_waitcnt lgkmcnt(10)
    v_mfma_f32_16x16x32_bf16 v[72:75], v[200:203], v[148:151], v[72:75]
    v_mfma_f32_16x16x32_bf16 v[80:83], v[200:203], v[156:159], v[80:83]
    v_mfma_f32_16x16x32_bf16 v[88:91], v[200:203], v[164:167], v[88:91]
    s_waitcnt lgkmcnt(8)
    v_mfma_f32_16x16x32_bf16 v[76:79], v[204:207], v[148:151], v[76:79]
    v_mfma_f32_16x16x32_bf16 v[84:87], v[204:207], v[156:159], v[84:87]
    v_mfma_f32_16x16x32_bf16 v[92:95], v[204:207], v[164:167], v[92:95]
    s_waitcnt lgkmcnt(6)
    v_mfma_f32_16x16x32_bf16 v[48:51], v[208:211], v[172:175], v[48:51]
    v_mfma_f32_16x16x32_bf16 v[56:59], v[208:211], v[180:183], v[56:59]
    v_mfma_f32_16x16x32_bf16 v[64:67], v[208:211], v[188:191], v[64:67]
    s_waitcnt lgkmcnt(4)
    v_mfma_f32_16x16x32_bf16 v[52:55], v[212:215], v[172:175], v[52:55]
    v_mfma_f32_16x16x32_bf16 v[60:63], v[212:215], v[180:183], v[60:63]
    v_mfma_f32_16x16x32_bf16 v[68:71], v[212:215], v[188:191], v[68:71]
    s_waitcnt lgkmcnt(2)
    v_mfma_f32_16x16x32_bf16 v[72:75], v[216:219], v[172:175], v[72:75]
    v_mfma_f32_16x16x32_bf16 v[80:83], v[216:219], v[180:183], v[80:83]
    v_mfma_f32_16x16x32_bf16 v[88:91], v[216:219], v[188:191], v[88:91]
    s_waitcnt lgkmcnt(0)
    v_mfma_f32_16x16x32_bf16 v[76:79], v[220:223], v[172:175], v[76:79]
    v_mfma_f32_16x16x32_bf16 v[84:87], v[220:223], v[180:183], v[84:87]
    v_mfma_f32_16x16x32_bf16 v[92:95], v[220:223], v[188:191], v[92:95]
    s_nop 7
    v_cvt_pk_bf16_f32 v48, v48, v49
    v_cvt_pk_bf16_f32 v49, v50, v51
    v_cvt_pk_bf16_f32 v50, v52, v53
    v_cvt_pk_bf16_f32 v51, v54, v55
    s_add_u32 s7, s87, 0
    buffer_store_dwordx4 v[48:51], v255, s[56:59], s7 offen sc1
    v_cvt_pk_bf16_f32 v56, v56, v57
    v_cvt_pk_bf16_f32 v57, v58, v59
    v_cvt_pk_bf16_f32 v58, v60, v61
    v_cvt_pk_bf16_f32 v59, v62, v63
    s_add_u32 s7, s87, 1024
    buffer_store_dwordx4 v[56:59], v255, s[56:59], s7 offen sc1
    v_cvt_pk_bf16_f32 v64, v64, v65
    v_cvt_pk_bf16_f32 v65, v66, v67
    v_cvt_pk_bf16_f32 v66, v68, v69
    v_cvt_pk_bf16_f32 v67, v70, v71
    s_add_u32 s7, s87, 2048
    buffer_store_dwordx4 v[64:67], v255, s[56:59], s7 offen sc1
    v_cvt_pk_bf16_f32 v72, v72, v73
    v_cvt_pk_bf16_f32 v73, v74, v75
    v_cvt_pk_bf16_f32 v74, v76, v77
    v_cvt_pk_bf16_f32 v75, v78, v79
    s_add_u32 s7, s87, 3072
    buffer_store_dwordx4 v[72:75], v255, s[56:59], s7 offen sc1
    v_cvt_pk_bf16_f32 v80, v80, v81
    v_cvt_pk_bf16_f32 v81, v82, v83
    v_cvt_pk_bf16_f32 v82, v84, v85
    v_cvt_pk_bf16_f32 v83, v86, v87
    s_add_u32 s7, s87, 4096
    buffer_store_dwordx4 v[80:83], v255, s[56:59], s7 offen sc1
    v_cvt_pk_bf16_f32 v88, v88, v89
    v_cvt_pk_bf16_f32 v89, v90, v91
    v_cvt_pk_bf16_f32 v90, v92, v93
    v_cvt_pk_bf16_f32 v91, v94, v95
    s_add_u32 s7, s87, 5120
    buffer_store_dwordx4 v[88:91], v255, s[56:59], s7 offen sc1
    s_endpgm
L_END:
    s_endpgm
.globl red_kernel
.p2align 8
.type red_kernel,@function
red_kernel:
    s_cmp_ge_u32 s2, 32
    s_cbranch_scc1 L_REND
    s_load_dwordx2 s[4:5], s[0:1], 80
    s_load_dwordx2 s[6:7], s[0:1], 96
    v_lshrrev_b32 v1, 6, v0
    v_and_b32 v0, 63, v0
    v_readfirstlane_b32 s8, v1
    s_nop 3
    s_mul_i32 s9, s2, 3
    s_add_u32 s8, s8, s9
    s_lshr_b32 s10, s3, 3
    s_and_b32 s11, s3, 7
    s_lshl_b32 s12, s10, 7
    s_add_u32 s12, s12, s11
    s_mul_i32 s12, s12, 98304
    s_lshl_b32 s13, s8, 10
    s_add_u32 s12, s12, s13
    v_lshlrev_b32 v1, 4, v0
    s_waitcnt lgkmcnt(0)
    s_add_u32 s16, s6, s12
    s_addc_u32 s17, s7, 0
    s_mov_b32 s18, 11797504
    s_mov_b32 s19, 0x00020000
    s_mov_b32 s14, 0
    buffer_load_dwordx4 v[8:11], v1, s[16:19], s14 offen
    s_add_u32 s14, s14, 786432
    buffer_load_dwordx4 v[12:15], v1, s[16:19], s14 offen
    s_add_u32 s14, s14, 786432
    buffer_load_dwordx4 v[16:19], v1, s[16:19], s14 offen
    s_add_u32 s14, s14, 786432
    buffer_load_dwordx4 v[20:23], v1, s[16:19], s14 offen
    s_add_u32 s14, s14, 786432
    buffer_load_dwordx4 v[24:27], v1, s[16:19], s14 offen
    s_add_u32 s14, s14, 786432
    buffer_load_dwordx4 v[28:31], v1, s[16:19], s14 offen
    s_add_u32 s14, s14, 786432
    buffer_load_dwordx4 v[32:35], v1, s[16:19], s14 offen
    s_add_u32 s14, s14, 786432
    buffer_load_dwordx4 v[36:39], v1, s[16:19], s14 offen
    s_add_u32 s14, s14, 786432
    buffer_load_dwordx4 v[40:43], v1, s[16:19], s14 offen
    s_add_u32 s14, s14, 786432
    buffer_load_dwordx4 v[44:47], v1, s[16:19], s14 offen
    s_add_u32 s14, s14, 786432
    buffer_load_dwordx4 v[48:51], v1, s[16:19], s14 offen
    s_add_u32 s14, s14, 786432
    buffer_load_dwordx4 v[52:55], v1, s[16:19], s14 offen
    s_add_u32 s14, s14, 786432
    buffer_load_dwordx4 v[56:59], v1, s[16:19], s14 offen
    s_add_u32 s14, s14, 786432
    buffer_load_dwordx4 v[60:63], v1, s[16:19], s14 offen
    s_add_u32 s14, s14, 786432
    buffer_load_dwordx4 v[64:67], v1, s[16:19], s14 offen
    s_add_u32 s14, s14, 786432
    buffer_load_dwordx4 v[68:71], v1, s[16:19], s14 offen
    s_mul_i32 s20, s8, 43
    s_lshr_b32 s20, s20, 8
    s_mul_i32 s21, s20, 6
    s_sub_u32 s21, s8, s21
    s_cmp_ge_u32 s21, 3
    s_cselect_b32 s22, 1, 0
    s_mul_i32 s23, s22, 3
    s_sub_u32 s23, s21, s23
    s_lshr_b32 s24, s20, 2
    s_and_b32 s25, s20, 3
    s_and_b32 s26, s24, 1
    s_lshr_b32 s27, s24, 1
    s_mul_i32 s28, s11, 96
    s_mul_i32 s29, s27, 48
    s_add_u32 s28, s28, s29
    s_lshl_b32 s29, s23, 4
    s_add_u32 s28, s28, s29
    s_lshl_b32 s28, s28, 11
    s_lshl_b32 s29, s10, 10
    s_add_u32 s28, s28, s29
    s_lshl_b32 s29, s26, 9
    s_add_u32 s28, s28, s29
    s_lshl_b32 s29, s25, 7
    s_add_u32 s28, s28, s29
    s_lshl_b32 s29, s22, 6
    s_add_u32 s28, s28, s29
    v_and_b32 v2, 15, v0
    v_lshlrev_b32 v2, 11, v2
    v_lshrrev_b32 v3, 4, v0
    v_and_b32 v4, 1, v3
    v_lshlrev_b32 v4, 5, v4
    v_lshrrev_b32 v3, 1, v3
    v_lshlrev_b32 v3, 4, v3
    v_add_u32 v2, v2, v3
    v_add_u32 v2, v2, v4
    v_add_u32 v2, s28, v2
    s_mov_b32 s8, s4
    s_mov_b32 s9, s5
    s_mov_b32 s10, 1572864
    s_mov_b32 s11, 0x00020000
    s_mov_b32 s30, 0xffff0000
    s_waitcnt vmcnt(15)
    v_lshlrev_b32 v72, 16, v8
    v_and_b32 v73, s30, v8
    v_lshlrev_b32 v74, 16, v9
    v_and_b32 v75, s30, v9
    v_lshlrev_b32 v76, 16, v10
    v_and_b32 v77, s30, v10
    v_lshlrev_b32 v78, 16, v11
    v_and_b32 v79, s30, v11
    s_waitcnt vmcnt(14)
    v_lshlrev_b32 v4, 16, v12
    v_and_b32 v5, s30, v12
    v_pk_add_f32 v[72:73], v[72:73], v[4:5]
    v_lshlrev_b32 v4, 16, v13
    v_and_b32 v5, s30, v13
    v_pk_add_f32 v[74:75], v[74:75], v[4:5]
    v_lshlrev_b32 v4, 16, v14
    v_and_b32 v5, s30, v14
    v_pk_add_f32 v[76:77], v[76:77], v[4:5]
    v_lshlrev_b32 v4, 16, v15
    v_and_b32 v5, s30, v15
    v_pk_add_f32 v[78:79], v[78:79], v[4:5]
    s_waitcnt vmcnt(13)
    v_lshlrev_b32 v4, 16, v16
    v_and_b32 v5, s30, v16
    v_pk_add_f32 v[72:73], v[72:73], v[4:5]
    v_lshlrev_b32 v4, 16, v17
    v_and_b32 v5, s30, v17
    v_pk_add_f32 v[74:75], v[74:75], v[4:5]
    v_lshlrev_b32 v4, 16, v18
    v_and_b32 v5, s30, v18
    v_pk_add_f32 v[76:77], v[76:77], v[4:5]
    v_lshlrev_b32 v4, 16, v19
    v_and_b32 v5, s30, v19
    v_pk_add_f32 v[78:79], v[78:79], v[4:5]
    s_waitcnt vmcnt(12)
    v_lshlrev_b32 v4, 16, v20
    v_and_b32 v5, s30, v20
    v_pk_add_f32 v[72:73], v[72:73], v[4:5]
    v_lshlrev_b32 v4, 16, v21
    v_and_b32 v5, s30, v21
    v_pk_add_f32 v[74:75], v[74:75], v[4:5]
    v_lshlrev_b32 v4, 16, v22
    v_and_b32 v5, s30, v22
    v_pk_add_f32 v[76:77], v[76:77], v[4:5]
    v_lshlrev_b32 v4, 16, v23
    v_and_b32 v5, s30, v23
    v_pk_add_f32 v[78:79], v[78:79], v[4:5]
    s_waitcnt vmcnt(11)
    v_lshlrev_b32 v4, 16, v24
    v_and_b32 v5, s30, v24
    v_pk_add_f32 v[72:73], v[72:73], v[4:5]
    v_lshlrev_b32 v4, 16, v25
    v_and_b32 v5, s30, v25
    v_pk_add_f32 v[74:75], v[74:75], v[4:5]
    v_lshlrev_b32 v4, 16, v26
    v_and_b32 v5, s30, v26
    v_pk_add_f32 v[76:77], v[76:77], v[4:5]
    v_lshlrev_b32 v4, 16, v27
    v_and_b32 v5, s30, v27
    v_pk_add_f32 v[78:79], v[78:79], v[4:5]
    s_waitcnt vmcnt(10)
    v_lshlrev_b32 v4, 16, v28
    v_and_b32 v5, s30, v28
    v_pk_add_f32 v[72:73], v[72:73], v[4:5]
    v_lshlrev_b32 v4, 16, v29
    v_and_b32 v5, s30, v29
    v_pk_add_f32 v[74:75], v[74:75], v[4:5]
    v_lshlrev_b32 v4, 16, v30
    v_and_b32 v5, s30, v30
    v_pk_add_f32 v[76:77], v[76:77], v[4:5]
    v_lshlrev_b32 v4, 16, v31
    v_and_b32 v5, s30, v31
    v_pk_add_f32 v[78:79], v[78:79], v[4:5]
    s_waitcnt vmcnt(9)
    v_lshlrev_b32 v4, 16, v32
    v_and_b32 v5, s30, v32
    v_pk_add_f32 v[72:73], v[72:73], v[4:5]
    v_lshlrev_b32 v4, 16, v33
    v_and_b32 v5, s30, v33
    v_pk_add_f32 v[74:75], v[74:75], v[4:5]
    v_lshlrev_b32 v4, 16, v34
    v_and_b32 v5, s30, v34
    v_pk_add_f32 v[76:77], v[76:77], v[4:5]
    v_lshlrev_b32 v4, 16, v35
    v_and_b32 v5, s30, v35
    v_pk_add_f32 v[78:79], v[78:79], v[4:5]
    s_waitcnt vmcnt(8)
    v_lshlrev_b32 v4, 16, v36
    v_and_b32 v5, s30, v36
    v_pk_add_f32 v[72:73], v[72:73], v[4:5]
    v_lshlrev_b32 v4, 16, v37
    v_and_b32 v5, s30, v37
    v_pk_add_f32 v[74:75], v[74:75], v[4:5]
    v_lshlrev_b32 v4, 16, v38
    v_and_b32 v5, s30, v38
    v_pk_add_f32 v[76:77], v[76:77], v[4:5]
    v_lshlrev_b32 v4, 16, v39
    v_and_b32 v5, s30, v39
    v_pk_add_f32 v[78:79], v[78:79], v[4:5]
    s_waitcnt vmcnt(7)
    v_lshlrev_b32 v4, 16, v40
    v_and_b32 v5, s30, v40
    v_pk_add_f32 v[72:73], v[72:73], v[4:5]
    v_lshlrev_b32 v4, 16, v41
    v_and_b32 v5, s30, v41
    v_pk_add_f32 v[74:75], v[74:75], v[4:5]
    v_lshlrev_b32 v4, 16, v42
    v_and_b32 v5, s30, v42
    v_pk_add_f32 v[76:77], v[76:77], v[4:5]
    v_lshlrev_b32 v4, 16, v43
    v_and_b32 v5, s30, v43
    v_pk_add_f32 v[78:79], v[78:79], v[4:5]
    s_waitcnt vmcnt(6)
    v_lshlrev_b32 v4, 16, v44
    v_and_b32 v5, s30, v44
    v_pk_add_f32 v[72:73], v[72:73], v[4:5]
    v_lshlrev_b32 v4, 16, v45
    v_and_b32 v5, s30, v45
    v_pk_add_f32 v[74:75], v[74:75], v[4:5]
    v_lshlrev_b32 v4, 16, v46
    v_and_b32 v5, s30, v46
    v_pk_add_f32 v[76:77], v[76:77], v[4:5]
    v_lshlrev_b32 v4, 16, v47
    v_and_b32 v5, s30, v47
    v_pk_add_f32 v[78:79], v[78:79], v[4:5]
    s_waitcnt vmcnt(5)
    v_lshlrev_b32 v4, 16, v48
    v_and_b32 v5, s30, v48
    v_pk_add_f32 v[72:73], v[72:73], v[4:5]
    v_lshlrev_b32 v4, 16, v49
    v_and_b32 v5, s30, v49
    v_pk_add_f32 v[74:75], v[74:75], v[4:5]
    v_lshlrev_b32 v4, 16, v50
    v_and_b32 v5, s30, v50
    v_pk_add_f32 v[76:77], v[76:77], v[4:5]
    v_lshlrev_b32 v4, 16, v51
    v_and_b32 v5, s30, v51
    v_pk_add_f32 v[78:79], v[78:79], v[4:5]
    s_waitcnt vmcnt(4)
    v_lshlrev_b32 v4, 16, v52
    v_and_b32 v5, s30, v52
    v_pk_add_f32 v[72:73], v[72:73], v[4:5]
    v_lshlrev_b32 v4, 16, v53
    v_and_b32 v5, s30, v53
    v_pk_add_f32 v[74:75], v[74:75], v[4:5]
    v_lshlrev_b32 v4, 16, v54
    v_and_b32 v5, s30, v54
    v_pk_add_f32 v[76:77], v[76:77], v[4:5]
    v_lshlrev_b32 v4, 16, v55
    v_and_b32 v5, s30, v55
    v_pk_add_f32 v[78:79], v[78:79], v[4:5]
    s_waitcnt vmcnt(3)
    v_lshlrev_b32 v4, 16, v56
    v_and_b32 v5, s30, v56
    v_pk_add_f32 v[72:73], v[72:73], v[4:5]
    v_lshlrev_b32 v4, 16, v57
    v_and_b32 v5, s30, v57
    v_pk_add_f32 v[74:75], v[74:75], v[4:5]
    v_lshlrev_b32 v4, 16, v58
    v_and_b32 v5, s30, v58
    v_pk_add_f32 v[76:77], v[76:77], v[4:5]
    v_lshlrev_b32 v4, 16, v59
    v_and_b32 v5, s30, v59
    v_pk_add_f32 v[78:79], v[78:79], v[4:5]
    s_waitcnt vmcnt(2)
    v_lshlrev_b32 v4, 16, v60
    v_and_b32 v5, s30, v60
    v_pk_add_f32 v[72:73], v[72:73], v[4:5]
    v_lshlrev_b32 v4, 16, v61
    v_and_b32 v5, s30, v61
    v_pk_add_f32 v[74:75], v[74:75], v[4:5]
    v_lshlrev_b32 v4, 16, v62
    v_and_b32 v5, s30, v62
    v_pk_add_f32 v[76:77], v[76:77], v[4:5]
    v_lshlrev_b32 v4, 16, v63
    v_and_b32 v5, s30, v63
    v_pk_add_f32 v[78:79], v[78:79], v[4:5]
    s_waitcnt vmcnt(1)
    v_lshlrev_b32 v4, 16, v64
    v_and_b32 v5, s30, v64
    v_pk_add_f32 v[72:73], v[72:73], v[4:5]
    v_lshlrev_b32 v4, 16, v65
    v_and_b32 v5, s30, v65
    v_pk_add_f32 v[74:75], v[74:75], v[4:5]
    v_lshlrev_b32 v4, 16, v66
    v_and_b32 v5, s30, v66
    v_pk_add_f32 v[76:77], v[76:77], v[4:5]
    v_lshlrev_b32 v4, 16, v67
    v_and_b32 v5, s30, v67
    v_pk_add_f32 v[78:79], v[78:79], v[4:5]
    s_waitcnt vmcnt(0)
    v_lshlrev_b32 v4, 16, v68
    v_and_b32 v5, s30, v68
    v_pk_add_f32 v[72:73], v[72:73], v[4:5]
    v_lshlrev_b32 v4, 16, v69
    v_and_b32 v5, s30, v69
    v_pk_add_f32 v[74:75], v[74:75], v[4:5]
    v_lshlrev_b32 v4, 16, v70
    v_and_b32 v5, s30, v70
    v_pk_add_f32 v[76:77], v[76:77], v[4:5]
    v_lshlrev_b32 v4, 16, v71
    v_and_b32 v5, s30, v71
    v_pk_add_f32 v[78:79], v[78:79], v[4:5]
    v_cvt_pk_bf16_f32 v80, v72, v73
    v_cvt_pk_bf16_f32 v81, v74, v75
    v_cvt_pk_bf16_f32 v82, v76, v77
    v_cvt_pk_bf16_f32 v83, v78, v79
    s_nop 1
    v_permlane16_swap_b32 v80, v82
    v_permlane16_swap_b32 v81, v83
    s_nop 1
    buffer_store_dwordx4 v[80:83], v2, s[8:11], 0 offen
L_REND:
    s_endpgm
.section .rodata,"a"
.p2align 6
.amdhsa_kernel concat_heads__mha_block_cached__gqa_block_cached__near_ridge_kernel
  .amdhsa_next_free_vgpr 256
  .amdhsa_next_free_sgpr 102
  .amdhsa_accum_offset 256
  .amdhsa_group_segment_fixed_size 0
  .amdhsa_kernarg_size 104
  .amdhsa_user_sgpr_count 2
  .amdhsa_user_sgpr_kernarg_segment_ptr 1
  .amdhsa_system_sgpr_workgroup_id_x 1
.end_amdhsa_kernel
.p2align 6
.amdhsa_kernel red_kernel
  .amdhsa_next_free_vgpr 88
  .amdhsa_next_free_sgpr 102
  .amdhsa_accum_offset 88
  .amdhsa_group_segment_fixed_size 0
  .amdhsa_kernarg_size 104
  .amdhsa_user_sgpr_count 2
  .amdhsa_user_sgpr_kernarg_segment_ptr 1
  .amdhsa_system_sgpr_workgroup_id_x 1
  .amdhsa_system_sgpr_workgroup_id_y 1
.end_amdhsa_kernel
```
